```python
import torch

def _softmax(x, axis=-1):
    return torch.softmax(x, dim=axis)
def _gelu(x):
    return torch.nn.functional.gelu(x, approximate="tanh")
def _silu(x):
    return torch.nn.functional.silu(x)
def _sigmoid(x):
    return torch.sigmoid(x)
def _layernorm(x, axis=-1, eps=1e-5):
    m = x.mean(dim=axis, keepdim=True)
    v = x.var(dim=axis, keepdim=True, unbiased=False)
    return (x - m) / torch.sqrt(v + eps)
def _scatter_add(tgt, idx, src, axis=0):
    return tgt.clone().index_add_(axis, idx, src)
def _segment_sum(src, seg, n):
    out = torch.zeros((n,) + src.shape[1:], dtype=src.dtype)
    return out.index_add_(0, seg, src)
def _pad(x, pw):
    flat = tuple(v for pair in reversed(pw) for v in pair)
    return torch.nn.functional.pad(x, flat)

kernel_name = 'gated_mix__sliding_block_cached__glu_gated_reglu__decode'

def setup_inputs():

    _w = (lambda a: (lambda t: t.to(torch.bfloat16) if t.is_floating_point() else t)(torch.as_tensor(a)))
    def _A_setup():
        B, Sq, D = 2, 1, 512
        Hq, Hkv, Sk, Dh = 32, 32, 4096, 128
        assert Hq % Hkv == 0, (Hq, Hkv)
        return {
            "x": _w((lambda *s: torch.randn(*s, dtype=torch.bfloat16) * 0.05)(B, Sq, D)),
            "k_cache": _w((lambda *s: torch.randn(*s, dtype=torch.bfloat16) * 3.2)(B, Hkv, Sk, Dh)),
            "v_cache": _w((lambda *s: torch.randn(*s, dtype=torch.bfloat16) * 0.05)(B, Hkv, Sk, Dh)),
            "wq": _w((lambda *s: torch.randn(*s, dtype=torch.bfloat16) * 3.2)(D, Hq * Dh) * (D ** -0.5)),
            "wo": _w((lambda *s: torch.randn(*s, dtype=torch.bfloat16) * 0.05)(Hq * Dh, D) * ((Hq * Dh) ** -0.5)),
        }
    _A_in = _A_setup()

    def _B_setup():
        B, S, D, F = 2, 1, 512, 1376
        return {
            "x": _w((lambda *s: torch.randn(*s, dtype=torch.bfloat16) * 0.05)(B, S, D)),
            "W_gate": _w((lambda *s: torch.randn(*s, dtype=torch.bfloat16) * 0.2)(D, F) * (2.0 / D) ** 0.5),
            "W_up": _w((lambda *s: torch.randn(*s, dtype=torch.bfloat16) * 0.2)(D, F) * (2.0 / D) ** 0.5),
            "W_down": _w((lambda *s: torch.randn(*s, dtype=torch.bfloat16) * 0.2)(F, D) * (1.0 / F) ** 0.5),
        }
    _B_in = _B_setup()

    return {
        "A_x": _A_in["x"],
        "A_k_cache": _A_in["k_cache"],
        "A_v_cache": _A_in["v_cache"],
        "A_wq": _A_in["wq"],
        "A_wo": _A_in["wo"],
        "B_x": _B_in["x"],
        "B_W_gate": _B_in["W_gate"],
        "B_W_up": _B_in["W_up"],
        "B_W_down": _B_in["W_down"],
        "gate_w": _w((lambda *s: torch.randn(*s, dtype=torch.bfloat16) * 0.05)(512) * 16.0),
    }

def reference(A_x, A_k_cache, A_v_cache, A_wq, A_wo, B_x, B_W_gate, B_W_up, B_W_down, gate_w):
    def _A_ref(x, k_cache, v_cache, wq, wo):
        B, Sq, D = x.shape
        Hq, Dh = 32, 128
        Hkv, Sk = k_cache.shape[1], k_cache.shape[2]
        W = min(4096, max(256, Sk // 4))
        rep = Hq // Hkv
        q = (lambda x, *d: x.permute(*d))((x @ wq).reshape(B, Sq, Hq, Dh), 0, 2, 1, 3)
        k = (lambda x, n, axis: torch.repeat_interleave(x, n, dim=axis))(k_cache[:, :, Sk - W:, :], rep, axis=1)
        v = (lambda x, n, axis: torch.repeat_interleave(x, n, dim=axis))(v_cache[:, :, Sk - W:, :], rep, axis=1)
        scores = torch.einsum("bhqd,bhkd->bhqk", q, k) * (Dh ** -0.5)
        p = _softmax(scores, axis=-1)
        o = torch.einsum("bhqk,bhkd->bhqd", p, v)
        return (lambda x, *d: x.permute(*d))(o, 0, 2, 1, 3).reshape(B, Sq, Hq * Dh) @ wo

    def _B_ref(x, W_gate, W_up, W_down):
        gate = torch.einsum("bsd,df->bsf", x, W_gate)
        up = torch.einsum("bsd,df->bsf", x, W_up)
        gate = gate * (lambda x, dt: x.to(dt))(gate > 0, gate.dtype)
        h = gate * up
        return torch.einsum("bsf,fd->bsd", h, W_down)

    x = A_x
    g = _sigmoid((x * gate_w).sum(-1, keepdims=True))
    a = _A_ref(x, A_k_cache, A_v_cache, A_wq, A_wo)
    b = _B_ref(x, B_W_gate, B_W_up, B_W_down)
    return g * a + (1 - g) * b
```

```asm
; @launch grid=(256,1,1) block=(768,1,1) lds=12800
.amdgcn_target "amdgcn-amd-amdhsa--gfx950"
.text
.globl gated_mix__sliding_block_cached__glu_gated_reglu__decode_kernel
.p2align 8
.type gated_mix__sliding_block_cached__glu_gated_reglu__decode_kernel,@function
gated_mix__sliding_block_cached__glu_gated_reglu__decode_kernel:
    s_cmp_ge_u32 s2, 256
    s_cbranch_scc1 L_end
    s_load_dwordx16 s[4:19], s[0:1], 0
    s_load_dwordx8 s[20:27], s[0:1], 64
    s_load_dwordx2 s[28:29], s[0:1], 96
    v_lshrrev_b32 v1, 6, v0
    v_and_b32 v0, 63, v0
    s_and_b32 s30, s2, 7
    v_readfirstlane_b32 s32, v1
    s_lshr_b32 s31, s2, 3
    s_lshr_b32 s33, s31, 3
    s_lshl_b32 s34, s30, 2
    s_add_u32 s33, s33, s34
    s_cmp_ge_u32 s32, 4
    s_cbranch_scc1 L_stream
    s_setprio 3
    s_mov_b32 s34, s32
    s_and_b32 s36, s31, 7
    v_lshrrev_b32 v1, 4, v0
    v_and_b32 v2, 15, v0
    v_lshlrev_b32 v3, 15, v1
    v_lshl_add_u32 v3, v2, 4, v3
    v_add_u32 v10, 8192, v3
    v_add_u32 v11, 16384, v3
    v_add_u32 v12, 24576, v3
    v_lshlrev_b32 v13, 3, v1
    s_lshl_b32 s37, s36, 6
    s_lshl_b32 s40, s34, 4
    s_add_u32 s37, s37, s40
    s_lshl_b32 s40, s37, 1
    s_lshl_b32 s37, s37, 13
    s_lshl_b32 s41, s33, 8
    s_add_u32 s37, s37, s41
    s_waitcnt lgkmcnt(0)
    s_add_u32 s44, s4, s40
    s_addc_u32 s45, s5, 0
    s_add_u32 s10, s10, s37
    s_addc_u32 s11, s11, 0
    global_load_dwordx2 v[4:5], v13, s[44:45]
    global_load_dwordx2 v[6:7], v13, s[44:45] offset:1024
    global_load_dwordx4 v[16:19], v3, s[10:11] nt
    global_load_dwordx4 v[20:23], v10, s[10:11] nt
    global_load_dwordx4 v[24:27], v11, s[10:11] nt
    global_load_dwordx4 v[28:31], v12, s[10:11] nt
    s_load_dword s14, s[28:29], 983040
    s_barrier
    s_mov_b32 s60, 0x03020107
    s_mov_b32 s61, 0x03020106
    s_mov_b32 s62, 0x03020105
    s_mov_b32 s63, 0x04000c0c
    s_mov_b32 s64, 0x0706000c
    s_mov_b32 s65, 0xffffff00
    s_mov_b32 s38, 0x05040100
    s_mov_b32 s39, 0x07060302
    v_mov_b32 v40, 0
    v_mov_b32 v41, 0
    v_mov_b32 v42, 0
    v_mov_b32 v43, 0
    v_mov_b32 v44, 0
    v_mov_b32 v45, 0
    v_mov_b32 v46, 0
    v_mov_b32 v47, 0
    v_mov_b32 v48, 0
    v_mov_b32 v49, 0
    v_mov_b32 v50, 0
    v_mov_b32 v51, 0
    v_mov_b32 v52, 0
    v_mov_b32 v53, 0
    v_mov_b32 v54, 0
    v_mov_b32 v55, 0
    v_lshrrev_b32 v1, 2, v0
    v_mul_u32_u24 v14, 5504, v1
    v_and_b32 v2, 3, v0
    v_lshl_add_u32 v14, v2, 4, v14
    v_lshlrev_b32 v15, 2, v1
    s_lshl_b32 s76, s31, 3
    s_add_u32 s76, s76, s30
    s_add_u32 s77, s76, 256
    s_cmp_lt_u32 s31, 11
    s_cselect_b32 s78, 2, 1
    s_cselect_b32 s77, s77, 0
    s_and_b32 s40, s76, 7
    s_lshl_b32 s40, s40, 6
    s_and_b32 s41, s34, 1
    s_lshl_b32 s41, s41, 5
    s_add_u32 s40, s40, s41
    s_lshl_b32 s41, s40, 1
    s_add_u32 s50, s4, s41
    s_addc_u32 s51, s5, 0
    s_mul_i32 s40, s40, 2752
    s_lshr_b32 s42, s76, 3
    s_lshl_b32 s42, s42, 6
    s_add_u32 s40, s40, s42
    s_cmp_ge_u32 s34, 2
    s_cselect_b32 s46, s18, s16
    s_cselect_b32 s47, s19, s17
    s_add_u32 s46, s46, s40
    s_addc_u32 s47, s47, 0
    s_and_b32 s40, s77, 7
    s_lshl_b32 s40, s40, 6
    s_and_b32 s41, s34, 1
    s_lshl_b32 s41, s41, 5
    s_add_u32 s40, s40, s41
    s_lshl_b32 s41, s40, 1
    s_add_u32 s80, s4, s41
    s_addc_u32 s81, s5, 0
    s_mul_i32 s40, s40, 2752
    s_lshr_b32 s42, s77, 3
    s_lshl_b32 s42, s42, 6
    s_add_u32 s40, s40, s42
    s_cmp_ge_u32 s34, 2
    s_cselect_b32 s82, s18, s16
    s_cselect_b32 s83, s19, s17
    s_add_u32 s82, s82, s40
    s_addc_u32 s83, s83, 0
    v_lshrrev_b32 v1, 5, v0
    v_lshlrev_b32 v10, 9, v1
    v_and_b32 v2, 15, v0
    v_lshl_add_u32 v10, v2, 5, v10
    v_bfe_u32 v2, v0, 4, 1
    v_lshl_add_u32 v10, v2, 4, v10
    s_lshl_b32 s40, s34, 10
    s_add_u32 s40, s40, 512
    v_add_u32 v11, s40, v10
    v_and_b32 v3, 3, v0
    v_lshlrev_b32 v12, 5, v3
    v_lshl_add_u32 v12, v2, 4, v12
    v_add_u32 v12, v12, v1
    s_and_b32 s40, s34, 1
    s_lshl_b32 s40, s40, 7
    s_lshr_b32 s41, s34, 1
    s_lshl_b32 s41, s41, 1
    s_add_u32 s40, s40, s41
    v_add_u32 v12, s40, v12
    v_lshlrev_b32 v12, 2, v12
    v_add_u32 v12, 4608, v12
    s_lshl_b32 s37, s33, 3
    s_add_u32 s37, s37, s36
    s_lshl_b32 s40, s37, 10
    s_add_u32 s44, s28, s40
    s_addc_u32 s45, s29, 0
    s_lshl_b32 s40, s30, 5
    s_and_b32 s41, s31, 24
    s_add_u32 s40, s40, s41
    s_lshl_b32 s40, s40, 7
    s_lshl_b32 s41, s36, 2
    s_add_u32 s40, s40, s41
    s_add_u32 s40, s40, 999424
    v_lshlrev_b32 v13, 7, v0
    v_add_u32 v13, s40, v13
    v_mov_b32 v1, 0
    v_mov_b32 v2, 1
    s_waitcnt lgkmcnt(0)
    s_add_u32 s14, s14, 1
    s_xor_b32 s15, s14, 0x5bd1e995
    s_getreg_b32 s58, hwreg(HW_REG_XCC_ID, 0, 4)
    s_add_u32 s58, s58, 1
    s_lshl_b32 s58, s58, 24
    s_cmp_eq_u32 s34, 1
    s_cbranch_scc0 L_a_noxt
    s_lshl_b32 s40, s30, 7
    s_lshl_b32 s41, s31, 2
    s_add_u32 s40, s40, s41
    s_add_u32 s40, s40, 991232
    s_xor_b32 s41, s15, s58
    v_mov_b32 v32, s40
    v_mov_b32 v33, s41
    s_mov_b64 exec, 1
    global_store_dword v32, v33, s[28:29] sc1
    s_mov_b64 exec, -1
    s_waitcnt vmcnt(3)
    s_branch L_a_xtj
L_a_noxt:
    s_waitcnt vmcnt(2)
L_a_xtj:
    v_perm_b32 v32, v20, v16, s38
    v_perm_b32 v33, v20, v16, s39
    v_perm_b32 v34, v21, v17, s38
    v_perm_b32 v35, v21, v17, s39
    v_perm_b32 v36, v22, v18, s38
    v_perm_b32 v37, v22, v18, s39
    v_perm_b32 v38, v23, v19, s38
    v_perm_b32 v39, v23, v19, s39
    v_dot2c_f32_bf16 v40, v32, v4
    v_dot2c_f32_bf16 v41, v33, v4
    v_dot2c_f32_bf16 v48, v32, v6
    v_dot2c_f32_bf16 v49, v33, v6
    v_dot2c_f32_bf16 v42, v34, v4
    v_dot2c_f32_bf16 v43, v35, v4
    v_dot2c_f32_bf16 v50, v34, v6
    v_dot2c_f32_bf16 v51, v35, v6
    v_dot2c_f32_bf16 v44, v36, v4
    v_dot2c_f32_bf16 v45, v37, v4
    v_dot2c_f32_bf16 v52, v36, v6
    v_dot2c_f32_bf16 v53, v37, v6
    v_dot2c_f32_bf16 v46, v38, v4
    v_dot2c_f32_bf16 v47, v39, v4
    v_dot2c_f32_bf16 v54, v38, v6
    v_dot2c_f32_bf16 v55, v39, v6
    s_cmp_eq_u32 s34, 1
    s_cbranch_scc0 L_a_noxt2
    s_waitcnt vmcnt(1)
    s_branch L_a_xtj2
L_a_noxt2:
    s_waitcnt vmcnt(0)
L_a_xtj2:
    v_perm_b32 v32, v28, v24, s38
    v_perm_b32 v33, v28, v24, s39
    v_perm_b32 v34, v29, v25, s38
    v_perm_b32 v35, v29, v25, s39
    v_perm_b32 v36, v30, v26, s38
    v_perm_b32 v37, v30, v26, s39
    v_perm_b32 v38, v31, v27, s38
    v_perm_b32 v39, v31, v27, s39
    v_dot2c_f32_bf16 v40, v32, v5
    v_dot2c_f32_bf16 v41, v33, v5
    v_dot2c_f32_bf16 v48, v32, v7
    v_dot2c_f32_bf16 v49, v33, v7
    v_dot2c_f32_bf16 v42, v34, v5
    v_dot2c_f32_bf16 v43, v35, v5
    v_dot2c_f32_bf16 v50, v34, v7
    v_dot2c_f32_bf16 v51, v35, v7
    v_dot2c_f32_bf16 v44, v36, v5
    v_dot2c_f32_bf16 v45, v37, v5
    v_dot2c_f32_bf16 v52, v36, v7
    v_dot2c_f32_bf16 v53, v37, v7
    v_dot2c_f32_bf16 v46, v38, v5
    v_dot2c_f32_bf16 v47, v39, v5
    v_dot2c_f32_bf16 v54, v38, v7
    v_dot2c_f32_bf16 v55, v39, v7
    s_nop 2
    v_permlane32_swap_b32 v40, v48
    v_permlane32_swap_b32 v41, v49
    v_permlane32_swap_b32 v42, v50
    v_permlane32_swap_b32 v43, v51
    v_permlane32_swap_b32 v44, v52
    v_permlane32_swap_b32 v45, v53
    v_permlane32_swap_b32 v46, v54
    v_permlane32_swap_b32 v47, v55
    v_add_f32 v40, v40, v48
    v_add_f32 v41, v41, v49
    v_add_f32 v42, v42, v50
    v_add_f32 v43, v43, v51
    v_add_f32 v44, v44, v52
    v_add_f32 v45, v45, v53
    v_add_f32 v46, v46, v54
    v_add_f32 v47, v47, v55
    v_permlane16_swap_b32 v40, v44
    v_permlane16_swap_b32 v41, v45
    v_permlane16_swap_b32 v42, v46
    v_permlane16_swap_b32 v43, v47
    v_add_f32 v40, v40, v44
    v_add_f32 v41, v41, v45
    v_add_f32 v42, v42, v46
    v_add_f32 v43, v43, v47
    ds_write_b128 v11, v[40:43]
    s_mov_b64 exec, 1
    ds_add_rtn_u32 v3, v1, v2 offset:0
    s_mov_b64 exec, -1
    v_add_u32 v11, 512, v10
    s_waitcnt lgkmcnt(0)
    v_readfirstlane_b32 s41, v3
    s_nop 0
    s_cmp_lg_u32 s41, 3
    s_cbranch_scc1 L_a_qnotlast
    ds_read_b128 v[16:19], v11
    ds_read_b128 v[20:23], v11 offset:1024
    ds_read_b128 v[24:27], v11 offset:2048
    ds_read_b128 v[28:31], v11 offset:3072
    v_mov_b32 v2, s15
    s_waitcnt lgkmcnt(2)
    v_add_f32 v16, v16, v20
    v_add_f32 v17, v17, v21
    v_add_f32 v18, v18, v22
    v_add_f32 v19, v19, v23
    s_waitcnt lgkmcnt(0)
    v_add_f32 v24, v24, v28
    v_add_f32 v25, v25, v29
    v_add_f32 v26, v26, v30
    v_add_f32 v27, v27, v31
    v_add_f32 v16, v16, v24
    v_add_f32 v17, v17, v25
    v_add_f32 v18, v18, v26
    v_add_f32 v19, v19, v27
    v_perm_b32 v20, v19, v16, s60
    v_perm_b32 v21, v19, v17, s61
    v_perm_b32 v22, v19, v18, s62
    v_mov_b32 v23, s15
    global_store_dwordx4 v10, v[20:23], s[44:45] sc1
    s_mov_b64 exec, 0xff
    global_store_dword v13, v2, s[28:29] sc1
    s_mov_b64 exec, -1
L_a_qnotlast:
    s_cmp_eq_u32 s78, 0
    s_cbranch_scc1 L_a_nof2
    global_load_dword v8, v15, s[50:51]
    global_load_dword v9, v15, s[50:51] offset:1024
    global_load_dwordx4 v[56:59], v14, s[46:47] nt
    global_load_dwordx4 v[60:63], v14, s[46:47] offset:2752 nt
    s_cmp_eq_u32 s78, 2
    s_cbranch_scc0 L_a_nof2
    global_load_dword v84, v15, s[80:81]
    global_load_dword v85, v15, s[80:81] offset:1024
    global_load_dwordx4 v[64:67], v14, s[82:83] nt
    global_load_dwordx4 v[68:71], v14, s[82:83] offset:2752 nt
L_a_nof2:
    s_lshr_b32 s41, s31, 2
    s_and_b32 s41, s41, 1
    s_lshl_b32 s41, s41, 9
    s_lshl_b32 s42, s33, 13
    s_add_u32 s41, s41, s42
    s_add_u32 s52, s28, s41
    s_addc_u32 s53, s29, 0
    s_cmp_eq_u32 s34, 0
    s_cbranch_scc0 L_a_not0
    s_lshl_b32 s40, s30, 5
    s_add_u32 s40, s40, s31
    s_lshl_b32 s40, s40, 7
    s_add_u32 s40, s40, 999424
    s_add_u32 s44, s28, s40
    s_addc_u32 s45, s29, 0
    v_and_b32 v1, 7, v0
    v_lshrrev_b32 v2, 3, v0
    v_lshlrev_b32 v3, 10, v1
    v_lshl_add_u32 v3, v2, 4, v3
    s_mov_b32 s35, 0
L_a_hspin:
    s_load_dwordx8 s[68:75], s[44:45], 0 glc
    s_add_u32 s35, s35, 1
    s_cmp_gt_u32 s35, 400000
    s_cbranch_scc1 L_end
    s_waitcnt lgkmcnt(0)
    s_xor_b32 s68, s68, s15
    s_xor_b32 s69, s69, s15
    s_or_b32 s68, s68, s69
    s_xor_b32 s70, s70, s15
    s_or_b32 s68, s68, s70
    s_xor_b32 s71, s71, s15
    s_or_b32 s68, s68, s71
    s_xor_b32 s72, s72, s15
    s_or_b32 s68, s68, s72
    s_xor_b32 s73, s73, s15
    s_or_b32 s68, s68, s73
    s_xor_b32 s74, s74, s15
    s_or_b32 s68, s68, s74
    s_xor_b32 s75, s75, s15
    s_or_b32 s68, s68, s75
    s_cmp_eq_u32 s68, 0
    s_cbranch_scc0 L_a_hspin
    global_load_dwordx4 v[16:19], v3, s[52:53] sc1
    global_load_dwordx4 v[20:23], v3, s[52:53] offset:128 sc1
    global_load_dwordx4 v[24:27], v3, s[52:53] offset:256 sc1
    global_load_dwordx4 v[28:31], v3, s[52:53] offset:384 sc1
    s_waitcnt vmcnt(4)
    s_branch L_a_ffn
L_a_not0:
    s_cmp_eq_u32 s34, 3
    s_cbranch_scc0 L_a_not3
    v_lshlrev_b32 v1, 4, v0
    global_load_dwordx4 v[72:75], v1, s[4:5]
    global_load_dwordx4 v[76:79], v1, s[4:5] offset:1024
    global_load_dwordx4 v[80:83], v1, s[22:23]
    s_waitcnt vmcnt(3)
    s_branch L_a_ffn
L_a_not3:
    s_waitcnt vmcnt(0)
L_a_ffn:
    s_cmp_eq_u32 s78, 0
    s_cbranch_scc1 L_a_nof2c
    v_mov_b32 v40, 0
    v_mov_b32 v41, 0
    v_mov_b32 v42, 0
    v_mov_b32 v43, 0
    v_mov_b32 v44, 0
    v_mov_b32 v45, 0
    v_mov_b32 v46, 0
    v_mov_b32 v47, 0
    v_mov_b32 v48, 0
    v_mov_b32 v49, 0
    v_mov_b32 v50, 0
    v_mov_b32 v51, 0
    v_mov_b32 v52, 0
    v_mov_b32 v53, 0
    v_mov_b32 v54, 0
    v_mov_b32 v55, 0
    v_perm_b32 v32, v60, v56, s38
    v_perm_b32 v33, v60, v56, s39
    v_perm_b32 v34, v61, v57, s38
    v_perm_b32 v35, v61, v57, s39
    v_perm_b32 v36, v62, v58, s38
    v_perm_b32 v37, v62, v58, s39
    v_perm_b32 v38, v63, v59, s38
    v_perm_b32 v39, v63, v59, s39
    v_dot2c_f32_bf16 v40, v32, v8
    v_dot2c_f32_bf16 v41, v33, v8
    v_dot2c_f32_bf16 v48, v32, v9
    v_dot2c_f32_bf16 v49, v33, v9
    v_dot2c_f32_bf16 v42, v34, v8
    v_dot2c_f32_bf16 v43, v35, v8
    v_dot2c_f32_bf16 v50, v34, v9
    v_dot2c_f32_bf16 v51, v35, v9
    v_dot2c_f32_bf16 v44, v36, v8
    v_dot2c_f32_bf16 v45, v37, v8
    v_dot2c_f32_bf16 v52, v36, v9
    v_dot2c_f32_bf16 v53, v37, v9
    v_dot2c_f32_bf16 v46, v38, v8
    v_dot2c_f32_bf16 v47, v39, v8
    v_dot2c_f32_bf16 v54, v38, v9
    v_dot2c_f32_bf16 v55, v39, v9
    s_nop 2
    v_permlane32_swap_b32 v40, v48
    v_permlane32_swap_b32 v41, v49
    v_permlane32_swap_b32 v42, v50
    v_permlane32_swap_b32 v43, v51
    v_permlane32_swap_b32 v44, v52
    v_permlane32_swap_b32 v45, v53
    v_permlane32_swap_b32 v46, v54
    v_permlane32_swap_b32 v47, v55
    v_add_f32 v40, v40, v48
    v_add_f32 v41, v41, v49
    v_add_f32 v42, v42, v50
    v_add_f32 v43, v43, v51
    v_add_f32 v44, v44, v52
    v_add_f32 v45, v45, v53
    v_add_f32 v46, v46, v54
    v_add_f32 v47, v47, v55
    v_permlane16_swap_b32 v40, v44
    v_permlane16_swap_b32 v41, v45
    v_permlane16_swap_b32 v42, v46
    v_permlane16_swap_b32 v43, v47
    v_add_f32 v40, v40, v44
    v_add_f32 v41, v41, v45
    v_add_f32 v42, v42, v46
    v_add_f32 v43, v43, v47
    s_nop 1
    v_add_f32_dpp v40, v40, v40 row_ror:8 row_mask:0xf bank_mask:0xf
    v_add_f32_dpp v41, v41, v41 row_ror:8 row_mask:0xf bank_mask:0xf
    v_add_f32_dpp v42, v42, v42 row_ror:8 row_mask:0xf bank_mask:0xf
    v_add_f32_dpp v43, v43, v43 row_ror:8 row_mask:0xf bank_mask:0xf
    v_add_f32_dpp v40, v40, v40 row_ror:4 row_mask:0xf bank_mask:0xf
    v_add_f32_dpp v41, v41, v41 row_ror:4 row_mask:0xf bank_mask:0xf
    v_add_f32_dpp v42, v42, v42 row_ror:4 row_mask:0xf bank_mask:0xf
    v_add_f32_dpp v43, v43, v43 row_ror:4 row_mask:0xf bank_mask:0xf
    s_mov_b32 exec_lo, 0xf000f
    s_mov_b32 exec_hi, 0xf000f
    ds_write2_b32 v12, v40, v41 offset0:0 offset1:4
    ds_write2_b32 v12, v42, v43 offset0:8 offset1:12
    s_mov_b64 exec, -1
    s_cmp_eq_u32 s78, 2
    s_cbranch_scc0 L_a_nof2c
    v_add_u32 v12, 1024, v12
    v_mov_b32 v40, 0
    v_mov_b32 v41, 0
    v_mov_b32 v42, 0
    v_mov_b32 v43, 0
    v_mov_b32 v44, 0
    v_mov_b32 v45, 0
    v_mov_b32 v46, 0
    v_mov_b32 v47, 0
    v_mov_b32 v48, 0
    v_mov_b32 v49, 0
    v_mov_b32 v50, 0
    v_mov_b32 v51, 0
    v_mov_b32 v52, 0
    v_mov_b32 v53, 0
    v_mov_b32 v54, 0
    v_mov_b32 v55, 0
    v_perm_b32 v32, v68, v64, s38
    v_perm_b32 v33, v68, v64, s39
    v_perm_b32 v34, v69, v65, s38
    v_perm_b32 v35, v69, v65, s39
    v_perm_b32 v36, v70, v66, s38
    v_perm_b32 v37, v70, v66, s39
    v_perm_b32 v38, v71, v67, s38
    v_perm_b32 v39, v71, v67, s39
    v_dot2c_f32_bf16 v40, v32, v84
    v_dot2c_f32_bf16 v41, v33, v84
    v_dot2c_f32_bf16 v48, v32, v85
    v_dot2c_f32_bf16 v49, v33, v85
    v_dot2c_f32_bf16 v42, v34, v84
    v_dot2c_f32_bf16 v43, v35, v84
    v_dot2c_f32_bf16 v50, v34, v85
    v_dot2c_f32_bf16 v51, v35, v85
    v_dot2c_f32_bf16 v44, v36, v84
    v_dot2c_f32_bf16 v45, v37, v84
    v_dot2c_f32_bf16 v52, v36, v85
    v_dot2c_f32_bf16 v53, v37, v85
    v_dot2c_f32_bf16 v46, v38, v84
    v_dot2c_f32_bf16 v47, v39, v84
    v_dot2c_f32_bf16 v54, v38, v85
    v_dot2c_f32_bf16 v55, v39, v85
    s_nop 2
    v_permlane32_swap_b32 v40, v48
    v_permlane32_swap_b32 v41, v49
    v_permlane32_swap_b32 v42, v50
    v_permlane32_swap_b32 v43, v51
    v_permlane32_swap_b32 v44, v52
    v_permlane32_swap_b32 v45, v53
    v_permlane32_swap_b32 v46, v54
    v_permlane32_swap_b32 v47, v55
    v_add_f32 v40, v40, v48
    v_add_f32 v41, v41, v49
    v_add_f32 v42, v42, v50
    v_add_f32 v43, v43, v51
    v_add_f32 v44, v44, v52
    v_add_f32 v45, v45, v53
    v_add_f32 v46, v46, v54
    v_add_f32 v47, v47, v55
    v_permlane16_swap_b32 v40, v44
    v_permlane16_swap_b32 v41, v45
    v_permlane16_swap_b32 v42, v46
    v_permlane16_swap_b32 v43, v47
    v_add_f32 v40, v40, v44
    v_add_f32 v41, v41, v45
    v_add_f32 v42, v42, v46
    v_add_f32 v43, v43, v47
    s_nop 1
    v_add_f32_dpp v40, v40, v40 row_ror:8 row_mask:0xf bank_mask:0xf
    v_add_f32_dpp v41, v41, v41 row_ror:8 row_mask:0xf bank_mask:0xf
    v_add_f32_dpp v42, v42, v42 row_ror:8 row_mask:0xf bank_mask:0xf
    v_add_f32_dpp v43, v43, v43 row_ror:8 row_mask:0xf bank_mask:0xf
    v_add_f32_dpp v40, v40, v40 row_ror:4 row_mask:0xf bank_mask:0xf
    v_add_f32_dpp v41, v41, v41 row_ror:4 row_mask:0xf bank_mask:0xf
    v_add_f32_dpp v42, v42, v42 row_ror:4 row_mask:0xf bank_mask:0xf
    v_add_f32_dpp v43, v43, v43 row_ror:4 row_mask:0xf bank_mask:0xf
    s_mov_b32 exec_lo, 0xf000f
    s_mov_b32 exec_hi, 0xf000f
    ds_write2_b32 v12, v40, v41 offset0:0 offset1:4
    ds_write2_b32 v12, v42, v43 offset0:8 offset1:12
    s_mov_b64 exec, -1
L_a_nof2c:
    v_mov_b32 v1, 0
    v_mov_b32 v2, 1
    s_mov_b64 exec, 1
    ds_add_u32 v1, v2 offset:16
    s_mov_b64 exec, -1
    s_cmp_eq_u32 s34, 2
    s_cbranch_scc0 L_a_not2
    s_cmp_eq_u32 s78, 0
    s_cbranch_scc1 L_a_p2done
    v_lshrrev_b32 v13, 5, v0
    v_and_b32 v14, 31, v0
    v_lshlrev_b32 v12, 10, v13
    v_lshl_add_u32 v12, v14, 4, v12
    v_add_u32 v12, 4608, v12
    s_lshl_b32 s40, s76, 9
    s_lshl_b32 s41, s77, 9
    v_mov_b32 v13, s40
    v_mov_b32 v15, s41
    v_cmp_gt_u32 vcc, 32, v0
    s_add_u32 s46, s28, 262144
    s_addc_u32 s47, s29, 0
    v_cndmask_b32 v13, v15, v13, vcc
    v_lshl_add_u32 v13, v14, 4, v13
    s_mov_b32 s35, 0
L_a_gpspin:
    ds_read_b32 v3, v1 offset:16
    s_add_u32 s35, s35, 1
    s_cmp_gt_u32 s35, 400000
    s_cbranch_scc1 L_end
    s_waitcnt lgkmcnt(0)
    v_readfirstlane_b32 s40, v3
    s_nop 0
    s_cmp_lt_u32 s40, 4
    s_cbranch_scc1 L_a_gpspin
    ds_read_b128 v[32:35], v12
    ds_read_b128 v[36:39], v12 offset:512
    s_cmp_eq_u32 s78, 2
    s_cselect_b32 s41, -1, 0
    s_waitcnt lgkmcnt(0)
    v_add_f32 v32, v32, v36
    v_add_f32 v33, v33, v37
    v_add_f32 v34, v34, v38
    v_add_f32 v35, v35, v39
    v_perm_b32 v36, v35, v32, s60
    v_perm_b32 v37, v35, v33, s61
    v_perm_b32 v38, v35, v34, s62
    v_mov_b32 v39, s15
    s_mov_b32 exec_hi, s41
    global_store_dwordx4 v13, v[36:39], s[46:47] sc1
    s_mov_b64 exec, -1
    s_branch L_a_p2done
L_a_not2:
    s_cmp_eq_u32 s34, 0
    s_cbranch_scc0 L_a_not0b
    s_mov_b32 s35, 0
L_a_qchk:
    s_waitcnt vmcnt(0)
    v_xor_b32 v32, s15, v19
    v_xor_b32 v33, s15, v23
    v_xor_b32 v34, s15, v27
    v_xor_b32 v35, s15, v31
    v_or3_b32 v32, v32, v33, v34
    v_or_b32 v32, v32, v35
    v_cmp_ne_u32 vcc, 0, v32
    s_cbranch_vccz L_a_qok
    global_load_dwordx4 v[16:19], v3, s[52:53] sc1
    global_load_dwordx4 v[20:23], v3, s[52:53] offset:128 sc1
    global_load_dwordx4 v[24:27], v3, s[52:53] offset:256 sc1
    global_load_dwordx4 v[28:31], v3, s[52:53] offset:384 sc1
    s_add_u32 s35, s35, 1
    s_cmp_gt_u32 s35, 400000
    s_cbranch_scc1 L_end
    s_branch L_a_qchk
L_a_qok:
    v_lshrrev_b32 v2, 3, v0
    v_lshlrev_b32 v2, 3, v2
    v_add_u32 v2, 128, v2
    v_perm_b32 v19, v16, v17, s63
    v_and_b32 v16, s65, v16
    v_and_b32 v17, s65, v17
    v_perm_b32 v19, v19, v18, s64
    v_and_b32 v18, s65, v18
    v_perm_b32 v23, v20, v21, s63
    v_and_b32 v20, s65, v20
    v_and_b32 v21, s65, v21
    v_perm_b32 v23, v23, v22, s64
    v_and_b32 v22, s65, v22
    v_perm_b32 v27, v24, v25, s63
    v_and_b32 v24, s65, v24
    v_and_b32 v25, s65, v25
    v_perm_b32 v27, v27, v26, s64
    v_and_b32 v26, s65, v26
    v_perm_b32 v31, v28, v29, s63
    v_and_b32 v28, s65, v28
    v_and_b32 v29, s65, v29
    v_perm_b32 v31, v31, v30, s64
    v_and_b32 v30, s65, v30
    v_add_f32_dpp v16, v16, v16 quad_perm:[1,0,3,2] row_mask:0xf bank_mask:0xf
    v_add_f32_dpp v17, v17, v17 quad_perm:[1,0,3,2] row_mask:0xf bank_mask:0xf
    v_add_f32_dpp v18, v18, v18 quad_perm:[1,0,3,2] row_mask:0xf bank_mask:0xf
    v_add_f32_dpp v19, v19, v19 quad_perm:[1,0,3,2] row_mask:0xf bank_mask:0xf
    v_add_f32_dpp v20, v20, v20 quad_perm:[1,0,3,2] row_mask:0xf bank_mask:0xf
    v_add_f32_dpp v21, v21, v21 quad_perm:[1,0,3,2] row_mask:0xf bank_mask:0xf
    v_add_f32_dpp v22, v22, v22 quad_perm:[1,0,3,2] row_mask:0xf bank_mask:0xf
    v_add_f32_dpp v23, v23, v23 quad_perm:[1,0,3,2] row_mask:0xf bank_mask:0xf
    v_add_f32_dpp v24, v24, v24 quad_perm:[1,0,3,2] row_mask:0xf bank_mask:0xf
    v_add_f32_dpp v25, v25, v25 quad_perm:[1,0,3,2] row_mask:0xf bank_mask:0xf
    v_add_f32_dpp v26, v26, v26 quad_perm:[1,0,3,2] row_mask:0xf bank_mask:0xf
    v_add_f32_dpp v27, v27, v27 quad_perm:[1,0,3,2] row_mask:0xf bank_mask:0xf
    v_add_f32_dpp v28, v28, v28 quad_perm:[1,0,3,2] row_mask:0xf bank_mask:0xf
    v_add_f32_dpp v29, v29, v29 quad_perm:[1,0,3,2] row_mask:0xf bank_mask:0xf
    v_add_f32_dpp v30, v30, v30 quad_perm:[1,0,3,2] row_mask:0xf bank_mask:0xf
    v_add_f32_dpp v31, v31, v31 quad_perm:[1,0,3,2] row_mask:0xf bank_mask:0xf
    v_add_f32_dpp v16, v16, v16 quad_perm:[2,3,0,1] row_mask:0xf bank_mask:0xf
    v_add_f32_dpp v17, v17, v17 quad_perm:[2,3,0,1] row_mask:0xf bank_mask:0xf
    v_add_f32_dpp v18, v18, v18 quad_perm:[2,3,0,1] row_mask:0xf bank_mask:0xf
    v_add_f32_dpp v19, v19, v19 quad_perm:[2,3,0,1] row_mask:0xf bank_mask:0xf
    v_add_f32_dpp v20, v20, v20 quad_perm:[2,3,0,1] row_mask:0xf bank_mask:0xf
    v_add_f32_dpp v21, v21, v21 quad_perm:[2,3,0,1] row_mask:0xf bank_mask:0xf
    v_add_f32_dpp v22, v22, v22 quad_perm:[2,3,0,1] row_mask:0xf bank_mask:0xf
    v_add_f32_dpp v23, v23, v23 quad_perm:[2,3,0,1] row_mask:0xf bank_mask:0xf
    v_add_f32_dpp v24, v24, v24 quad_perm:[2,3,0,1] row_mask:0xf bank_mask:0xf
    v_add_f32_dpp v25, v25, v25 quad_perm:[2,3,0,1] row_mask:0xf bank_mask:0xf
    v_add_f32_dpp v26, v26, v26 quad_perm:[2,3,0,1] row_mask:0xf bank_mask:0xf
    v_add_f32_dpp v27, v27, v27 quad_perm:[2,3,0,1] row_mask:0xf bank_mask:0xf
    v_add_f32_dpp v28, v28, v28 quad_perm:[2,3,0,1] row_mask:0xf bank_mask:0xf
    v_add_f32_dpp v29, v29, v29 quad_perm:[2,3,0,1] row_mask:0xf bank_mask:0xf
    v_add_f32_dpp v30, v30, v30 quad_perm:[2,3,0,1] row_mask:0xf bank_mask:0xf
    v_add_f32_dpp v31, v31, v31 quad_perm:[2,3,0,1] row_mask:0xf bank_mask:0xf
    v_add_f32_dpp v16, v16, v16 row_half_mirror row_mask:0xf bank_mask:0xf
    v_add_f32_dpp v17, v17, v17 row_half_mirror row_mask:0xf bank_mask:0xf
    v_add_f32_dpp v18, v18, v18 row_half_mirror row_mask:0xf bank_mask:0xf
    v_add_f32_dpp v19, v19, v19 row_half_mirror row_mask:0xf bank_mask:0xf
    v_add_f32_dpp v20, v20, v20 row_half_mirror row_mask:0xf bank_mask:0xf
    v_add_f32_dpp v21, v21, v21 row_half_mirror row_mask:0xf bank_mask:0xf
    v_add_f32_dpp v22, v22, v22 row_half_mirror row_mask:0xf bank_mask:0xf
    v_add_f32_dpp v23, v23, v23 row_half_mirror row_mask:0xf bank_mask:0xf
    v_add_f32_dpp v24, v24, v24 row_half_mirror row_mask:0xf bank_mask:0xf
    v_add_f32_dpp v25, v25, v25 row_half_mirror row_mask:0xf bank_mask:0xf
    v_add_f32_dpp v26, v26, v26 row_half_mirror row_mask:0xf bank_mask:0xf
    v_add_f32_dpp v27, v27, v27 row_half_mirror row_mask:0xf bank_mask:0xf
    v_add_f32_dpp v28, v28, v28 row_half_mirror row_mask:0xf bank_mask:0xf
    v_add_f32_dpp v29, v29, v29 row_half_mirror row_mask:0xf bank_mask:0xf
    v_add_f32_dpp v30, v30, v30 row_half_mirror row_mask:0xf bank_mask:0xf
    v_add_f32_dpp v31, v31, v31 row_half_mirror row_mask:0xf bank_mask:0xf
    v_cvt_pk_bf16_f32 v32, v16, v17
    v_cvt_pk_bf16_f32 v33, v18, v19
    v_cvt_pk_bf16_f32 v34, v20, v21
    v_cvt_pk_bf16_f32 v35, v22, v23
    v_cvt_pk_bf16_f32 v36, v24, v25
    v_cvt_pk_bf16_f32 v37, v26, v27
    v_cvt_pk_bf16_f32 v38, v28, v29
    v_cvt_pk_bf16_f32 v39, v30, v31
    s_mov_b32 exec_lo, 0x1010101
    s_mov_b32 exec_hi, 0x1010101
    ds_write_b64 v2, v[32:33]
    ds_write_b64 v2, v[34:35] offset:64
    ds_write_b64 v2, v[36:37] offset:128
    ds_write_b64 v2, v[38:39] offset:192
    v_mov_b32 v1, 0
    v_mov_b32 v2, 1
    s_mov_b64 exec, 1
    ds_write_b32 v1, v2 offset:20
    s_mov_b64 exec, -1
    s_branch L_a_p2done
L_a_not0b:
    s_cmp_eq_u32 s34, 3
    s_cbranch_scc0 L_a_p2done
    v_mov_b32 v20, 0
    v_mov_b32 v21, 0
    s_waitcnt vmcnt(0)
    v_dot2c_f32_bf16 v20, v72, v80
    v_dot2c_f32_bf16 v21, v76, v80
    v_dot2c_f32_bf16 v20, v73, v81
    v_dot2c_f32_bf16 v21, v77, v81
    v_dot2c_f32_bf16 v20, v74, v82
    v_dot2c_f32_bf16 v21, v78, v82
    v_dot2c_f32_bf16 v20, v75, v83
    v_dot2c_f32_bf16 v21, v79, v83
    s_nop 2
    v_permlane32_swap_b32 v20, v21
    v_add_f32 v20, v20, v21
    v_mov_b32 v21, v20
    s_nop 1
    v_permlane16_swap_b32 v20, v21
    v_add_f32 v20, v20, v21
    s_nop 1
    v_add_f32_dpp v20, v20, v20 row_ror:8 row_mask:0xf bank_mask:0xf
    s_nop 1
    v_add_f32_dpp v20, v20, v20 row_ror:4 row_mask:0xf bank_mask:0xf
    s_nop 1
    v_add_f32_dpp v20, v20, v20 row_ror:2 row_mask:0xf bank_mask:0xf
    s_nop 1
    v_add_f32_dpp v20, v20, v20 row_ror:1 row_mask:0xf bank_mask:0xf
    s_nop 1
    v_cvt_pk_bf16_f32 v20, v20, v20
    v_and_b32 v20, 0xffff0000, v20
    v_mul_f32 v20, 0xbfb8aa3b, v20
    v_exp_f32 v20, v20
    s_nop 0
    v_add_f32 v20, 1.0, v20
    v_rcp_f32 v20, v20
    s_nop 0
    v_cvt_pk_bf16_f32 v20, v20, v20
    v_and_b32 v20, 0xffff0000, v20
    v_sub_f32 v21, 1.0, v20
    v_cvt_pk_bf16_f32 v21, v21, v21
    v_and_b32 v21, 0xffff0000, v21
    v_lshrrev_b32 v22, 5, v0
    v_lshlrev_b32 v22, 2, v22
    s_mov_b32 exec_lo, 0x1
    s_mov_b32 exec_hi, 0x1
    ds_write_b32 v22, v20 offset:32
    ds_write_b32 v22, v21 offset:40
    v_mov_b32 v1, 0
    v_mov_b32 v2, 1
    s_mov_b64 exec, 1
    ds_write_b32 v1, v2 offset:24
    s_mov_b64 exec, -1
L_a_p2done:
    v_and_b32 v1, 7, v0
    v_lshrrev_b32 v2, 3, v0
    v_lshlrev_b32 v3, 9, v1
    v_lshl_add_u32 v3, v2, 4, v3
    v_lshlrev_b32 v10, 10, v2
    v_lshl_add_u32 v10, v1, 4, v10
    v_add_u32 v11, 8192, v10
    v_add_u32 v12, 16384, v10
    v_add_u32 v13, 24576, v10
    v_add_u32 v14, 0x20000, v3
    v_add_u32 v15, 0x100000, v10
    s_lshl_b32 s36, s31, 12
    s_lshl_b32 s37, s34, 7
    s_add_u32 s36, s36, s37
    s_add_u32 s40, s36, 262144
    s_add_u32 s44, s28, s40
    s_addc_u32 s45, s29, 0
    s_add_u32 s40, s36, 524288
    s_add_u32 s48, s28, s40
    s_addc_u32 s49, s29, 0
    s_lshl_b32 s40, s31, 5
    s_lshl_b32 s41, s34, 3
    s_add_u32 s40, s40, s41
    s_lshl_b32 s40, s40, 10
    s_lshl_b32 s41, s30, 7
    s_add_u32 s40, s40, s41
    s_add_u32 s20, s20, s40
    s_addc_u32 s21, s21, 0
    s_lshl_b32 s40, s31, 7
    s_lshl_b32 s42, s34, 5
    s_add_u32 s40, s40, s42
    s_lshl_b32 s40, s40, 10
    s_add_u32 s40, s40, s41
    s_add_u32 s12, s12, s40
    s_addc_u32 s13, s13, 0
    v_lshrrev_b32 v4, 5, v0
    v_lshlrev_b32 v5, 8, v4
    v_lshl_add_u32 v5, v1, 5, v5
    v_bfe_u32 v4, v0, 4, 1
    v_lshl_add_u32 v5, v4, 4, v5
    s_lshl_b32 s40, s34, 9
    s_add_u32 s40, s40, 10752
    v_add_u32 v93, s40, v5
    v_and_b32 v5, 31, v0
    v_lshlrev_b32 v6, 4, v5
    v_lshlrev_b32 v7, 9, v5
    v_add_u32 v8, 10752, v6
    v_add_u32 v9, 131072, v6
    v_lshlrev_b32 v104, 2, v5
    s_lshl_b32 s40, s30, 7
    s_add_u32 s40, s40, 991232
    s_add_u32 s66, s28, s40
    s_addc_u32 s67, s29, 0
    global_load_dword v105, v104, s[66:67] sc1
    s_lshl_b32 s40, s30, 5
    s_add_u32 s40, s40, s31
    s_lshl_b32 s40, s40, 9
    s_add_u32 s40, s40, 720896
    s_add_u32 s54, s28, s40
    s_addc_u32 s55, s29, 0
    s_lshl_b32 s40, s30, 14
    s_lshl_b32 s41, s31, 4
    s_add_u32 s40, s40, s41
    s_add_u32 s40, s40, 720896
    s_add_u32 s46, s28, s40
    s_addc_u32 s47, s29, 0
    s_lshr_b32 s40, s31, 4
    s_lshl_b32 s40, s40, 10
    s_lshl_b32 s41, s30, 7
    s_add_u32 s40, s40, s41
    s_and_b32 s41, s31, 15
    s_lshl_b32 s41, s41, 3
    s_add_u32 s40, s40, s41
    s_add_u32 s24, s24, s40
    s_addc_u32 s25, s25, 0
    s_mov_b32 s42, 0xf0f0f0f0
    s_mov_b32 s43, 0xf0f0f0f0
    v_mov_b32 v94, 0
    v_mov_b32 v95, 1
    v_mov_b32 v40, 0
    v_mov_b32 v41, 0
    v_mov_b32 v42, 0
    v_mov_b32 v43, 0
    v_mov_b32 v44, 0
    v_mov_b32 v45, 0
    v_mov_b32 v46, 0
    v_mov_b32 v47, 0
    v_mov_b32 v48, 0
    v_mov_b32 v49, 0
    v_mov_b32 v50, 0
    v_mov_b32 v51, 0
    v_mov_b32 v52, 0
    v_mov_b32 v53, 0
    v_mov_b32 v54, 0
    v_mov_b32 v55, 0
    s_waitcnt lgkmcnt(0)
    s_setprio 0
    s_mov_b32 s35, 0
L_a_vspin:
    s_sleep 2
    ds_read_b32 v1, v94 offset:4
    ds_read_b32 v2, v94 offset:24
    s_add_u32 s35, s35, 1
    s_cmp_gt_u32 s35, 400000
    s_cbranch_scc1 L_end
    s_waitcnt lgkmcnt(0)
    v_readfirstlane_b32 s40, v1
    v_readfirstlane_b32 s41, v2
    s_nop 0
    s_lshl_b32 s41, s41, 3
    s_and_b32 s40, s40, s41
    s_cmp_eq_u32 s40, 8
    s_cbranch_scc0 L_a_vspin
    s_setprio 3
    global_load_dwordx4 v[16:19], v3, s[44:45] sc1
    global_load_dwordx4 v[24:27], v10, s[20:21] nt
    s_cmp_lt_u32 s31, 11
    s_cbranch_scc0 L_a_p3light
    global_load_dwordx4 v[20:23], v14, s[44:45] sc1
    global_load_dwordx4 v[28:31], v15, s[20:21] nt
L_a_p3light:
    ds_read_b128 v[88:91], v94 offset:32
    s_mov_b32 s35, 0
    s_setprio 0
L_a_pspin:
    s_sleep 1
    ds_read_b32 v1, v94 offset:8
    s_add_u32 s35, s35, 1
    s_cmp_gt_u32 s35, 400000
    s_cbranch_scc1 L_end
    s_waitcnt lgkmcnt(0)
    v_readfirstlane_b32 s40, v1
    s_nop 0
    s_cmp_lt_u32 s40, 8
    s_cbranch_scc1 L_a_pspin
    s_setprio 3
    global_load_dwordx4 v[56:59], v10, s[12:13] nt
    global_load_dwordx4 v[60:63], v11, s[12:13] nt
    global_load_dwordx4 v[64:67], v12, s[12:13] nt
    global_load_dwordx4 v[68:71], v13, s[12:13] nt
    s_setprio 1
    s_waitcnt vmcnt(4)
    s_mov_b32 s35, 0
L_a_gchk:
    v_xor_b32 v32, s15, v19
    s_cmp_lt_u32 s31, 11
    s_cbranch_scc0 L_a_gchk1
    v_xor_b32 v33, s15, v23
    v_or_b32 v32, v32, v33
L_a_gchk1:
    v_cmp_ne_u32 vcc, 0, v32
    s_cbranch_vccz L_a_gok
    global_load_dwordx4 v[16:19], v3, s[44:45] sc1
    s_cmp_lt_u32 s31, 11
    s_cbranch_scc0 L_a_gre1
    global_load_dwordx4 v[20:23], v14, s[44:45] sc1
L_a_gre1:
    s_add_u32 s35, s35, 1
    s_cmp_gt_u32 s35, 400000
    s_cbranch_scc1 L_end
    s_waitcnt vmcnt(0)
    s_branch L_a_gchk
L_a_gok:
    s_xor_b32 s40, s15, s58
    v_add_u32 v104, 131072, v7
    v_cmp_eq_u32 vcc, s40, v105
    s_nop 1
    v_cndmask_b32 v106, v104, v7, vcc
    v_cndmask_b32 v7, v7, v104, vcc
    s_mov_b32 s59, vcc_lo
    v_perm_b32 v19, v16, v17, s63
    v_and_b32 v16, s65, v16
    v_and_b32 v17, s65, v17
    v_perm_b32 v19, v19, v18, s64
    v_and_b32 v18, s65, v18
    v_add_f32_dpp v16, v16, v16 quad_perm:[1,0,3,2] row_mask:0xf bank_mask:0xf
    v_add_f32_dpp v17, v17, v17 quad_perm:[1,0,3,2] row_mask:0xf bank_mask:0xf
    v_add_f32_dpp v18, v18, v18 quad_perm:[1,0,3,2] row_mask:0xf bank_mask:0xf
    v_add_f32_dpp v19, v19, v19 quad_perm:[1,0,3,2] row_mask:0xf bank_mask:0xf
    v_add_f32_dpp v16, v16, v16 quad_perm:[2,3,0,1] row_mask:0xf bank_mask:0xf
    v_add_f32_dpp v17, v17, v17 quad_perm:[2,3,0,1] row_mask:0xf bank_mask:0xf
    v_add_f32_dpp v18, v18, v18 quad_perm:[2,3,0,1] row_mask:0xf bank_mask:0xf
    v_add_f32_dpp v19, v19, v19 quad_perm:[2,3,0,1] row_mask:0xf bank_mask:0xf
    v_add_f32_dpp v16, v16, v16 row_half_mirror row_mask:0xf bank_mask:0xf
    v_add_f32_dpp v17, v17, v17 row_half_mirror row_mask:0xf bank_mask:0xf
    v_add_f32_dpp v18, v18, v18 row_half_mirror row_mask:0xf bank_mask:0xf
    v_add_f32_dpp v19, v19, v19 row_half_mirror row_mask:0xf bank_mask:0xf
    v_cvt_pk_bf16_f32 v32, v16, v17
    v_cvt_pk_bf16_f32 v33, v18, v19
    v_lshlrev_b32 v34, 16, v32
    v_and_b32 v35, 0xffff0000, v32
    v_lshlrev_b32 v36, 16, v33
    v_and_b32 v37, 0xffff0000, v33
    v_cmp_lt_f32 vcc, 0, v34
    v_cmp_lt_f32 s[56:57], 0, v35
    s_nop 1
    v_cndmask_b32 v38, 0, 1.0, vcc
    v_cndmask_b32 v39, 0, 1.0, s[56:57]
    v_mul_f32 v34, v34, v38
    v_mul_f32 v35, v35, v39
    v_mul_f32 v34, v34, v36
    v_mul_f32 v35, v35, v37
    v_cvt_pk_bf16_f32 v84, v34, 0
    v_cvt_pk_bf16_f32 v85, v35, 0
    v_lshlrev_b32 v86, 16, v84
    v_lshlrev_b32 v87, 16, v85
    v_dot2c_f32_bf16 v40, v24, v84
    v_dot2c_f32_bf16 v41, v24, v86
    v_dot2c_f32_bf16 v48, v24, v85
    v_dot2c_f32_bf16 v49, v24, v87
    v_dot2c_f32_bf16 v42, v25, v84
    v_dot2c_f32_bf16 v43, v25, v86
    v_dot2c_f32_bf16 v50, v25, v85
    v_dot2c_f32_bf16 v51, v25, v87
    v_dot2c_f32_bf16 v44, v26, v84
    v_dot2c_f32_bf16 v45, v26, v86
    v_dot2c_f32_bf16 v52, v26, v85
    v_dot2c_f32_bf16 v53, v26, v87
    v_dot2c_f32_bf16 v46, v27, v84
    v_dot2c_f32_bf16 v47, v27, v86
    v_dot2c_f32_bf16 v54, v27, v85
    v_dot2c_f32_bf16 v55, v27, v87
    s_cmp_lt_u32 s31, 11
    s_cbranch_scc0 L_a_p3light2
    v_perm_b32 v23, v20, v21, s63
    v_and_b32 v20, s65, v20
    v_and_b32 v21, s65, v21
    v_perm_b32 v23, v23, v22, s64
    v_and_b32 v22, s65, v22
    v_add_f32_dpp v20, v20, v20 quad_perm:[1,0,3,2] row_mask:0xf bank_mask:0xf
    v_add_f32_dpp v21, v21, v21 quad_perm:[1,0,3,2] row_mask:0xf bank_mask:0xf
    v_add_f32_dpp v22, v22, v22 quad_perm:[1,0,3,2] row_mask:0xf bank_mask:0xf
    v_add_f32_dpp v23, v23, v23 quad_perm:[1,0,3,2] row_mask:0xf bank_mask:0xf
    v_add_f32_dpp v20, v20, v20 quad_perm:[2,3,0,1] row_mask:0xf bank_mask:0xf
    v_add_f32_dpp v21, v21, v21 quad_perm:[2,3,0,1] row_mask:0xf bank_mask:0xf
    v_add_f32_dpp v22, v22, v22 quad_perm:[2,3,0,1] row_mask:0xf bank_mask:0xf
    v_add_f32_dpp v23, v23, v23 quad_perm:[2,3,0,1] row_mask:0xf bank_mask:0xf
    v_add_f32_dpp v20, v20, v20 row_half_mirror row_mask:0xf bank_mask:0xf
    v_add_f32_dpp v21, v21, v21 row_half_mirror row_mask:0xf bank_mask:0xf
    v_add_f32_dpp v22, v22, v22 row_half_mirror row_mask:0xf bank_mask:0xf
    v_add_f32_dpp v23, v23, v23 row_half_mirror row_mask:0xf bank_mask:0xf
    v_cvt_pk_bf16_f32 v32, v20, v21
    v_cvt_pk_bf16_f32 v33, v22, v23
    v_lshlrev_b32 v34, 16, v32
    v_and_b32 v35, 0xffff0000, v32
    v_lshlrev_b32 v36, 16, v33
    v_and_b32 v37, 0xffff0000, v33
    v_cmp_lt_f32 vcc, 0, v34
    v_cmp_lt_f32 s[56:57], 0, v35
    s_nop 1
    v_cndmask_b32 v38, 0, 1.0, vcc
    v_cndmask_b32 v39, 0, 1.0, s[56:57]
    v_mul_f32 v34, v34, v38
    v_mul_f32 v35, v35, v39
    v_mul_f32 v34, v34, v36
    v_mul_f32 v35, v35, v37
    v_cvt_pk_bf16_f32 v84, v34, 0
    v_cvt_pk_bf16_f32 v85, v35, 0
    v_lshlrev_b32 v86, 16, v84
    v_lshlrev_b32 v87, 16, v85
    v_dot2c_f32_bf16 v40, v28, v84
    v_dot2c_f32_bf16 v41, v28, v86
    v_dot2c_f32_bf16 v48, v28, v85
    v_dot2c_f32_bf16 v49, v28, v87
    v_dot2c_f32_bf16 v42, v29, v84
    v_dot2c_f32_bf16 v43, v29, v86
    v_dot2c_f32_bf16 v50, v29, v85
    v_dot2c_f32_bf16 v51, v29, v87
    v_dot2c_f32_bf16 v44, v30, v84
    v_dot2c_f32_bf16 v45, v30, v86
    v_dot2c_f32_bf16 v52, v30, v85
    v_dot2c_f32_bf16 v53, v30, v87
    v_dot2c_f32_bf16 v46, v31, v84
    v_dot2c_f32_bf16 v47, v31, v86
    v_dot2c_f32_bf16 v54, v31, v85
    v_dot2c_f32_bf16 v55, v31, v87
L_a_p3light2:
    s_waitcnt lgkmcnt(0)
    v_cndmask_b32 v92, v88, v89, s[42:43]
    s_nop 0
    v_mul_f32 v40, v40, v90
    v_mul_f32 v41, v41, v90
    v_mul_f32 v42, v42, v90
    v_mul_f32 v43, v43, v90
    v_mul_f32 v44, v44, v90
    v_mul_f32 v45, v45, v90
    v_mul_f32 v46, v46, v90
    v_mul_f32 v47, v47, v90
    v_mul_f32 v48, v48, v91
    v_mul_f32 v49, v49, v91
    v_mul_f32 v50, v50, v91
    v_mul_f32 v51, v51, v91
    v_mul_f32 v52, v52, v91
    v_mul_f32 v53, v53, v91
    v_mul_f32 v54, v54, v91
    v_mul_f32 v55, v55, v91
    s_setprio 3
    s_mov_b32 s35, 0
    s_waitcnt vmcnt(0)
    global_load_dwordx4 v[16:19], v3, s[48:49] sc1
    v_perm_b32 v72, v60, v56, s38
    v_perm_b32 v73, v60, v56, s39
    v_perm_b32 v74, v61, v57, s38
    v_perm_b32 v75, v61, v57, s39
    v_perm_b32 v76, v62, v58, s38
    v_perm_b32 v77, v62, v58, s39
    v_perm_b32 v78, v63, v59, s38
    v_perm_b32 v79, v63, v59, s39
    v_perm_b32 v80, v68, v64, s38
    v_perm_b32 v81, v68, v64, s39
    v_perm_b32 v82, v69, v65, s38
    v_perm_b32 v83, v69, v65, s39
    v_perm_b32 v84, v70, v66, s38
    v_perm_b32 v85, v70, v66, s39
    v_perm_b32 v86, v71, v67, s38
    v_perm_b32 v87, v71, v67, s39
    s_branch L_a_ochk
L_a_ospin:
    global_load_dwordx4 v[16:19], v3, s[48:49] sc1
L_a_ochk:
    s_add_u32 s35, s35, 1
    s_cmp_gt_u32 s35, 400000
    s_cbranch_scc1 L_end
    s_waitcnt vmcnt(0)
    v_cmp_ne_u32 vcc, s15, v19
    s_cbranch_vccnz L_a_ospin
    v_max_f32_dpp v22, v18, v18 quad_perm:[1,0,3,2] row_mask:0xf bank_mask:0xf
    v_lshlrev_b32 v20, 16, v17
    v_and_b32 v21, 0xffff0000, v17
    v_max_f32_dpp v22, v22, v22 quad_perm:[2,3,0,1] row_mask:0xf bank_mask:0xf
    v_and_b32 v17, 0xffff0000, v16
    v_sub_f32 v22, v18, v22
    v_exp_f32 v22, v22
    v_lshlrev_b32 v16, 16, v16
    v_mul_f32 v24, v22, v92
    v_add_f32_dpp v23, v22, v22 quad_perm:[1,0,3,2] row_mask:0xf bank_mask:0xf
    v_mul_f32 v16, v16, v24
    v_mul_f32 v17, v17, v24
    v_add_f32_dpp v23, v23, v23 quad_perm:[2,3,0,1] row_mask:0xf bank_mask:0xf
    v_mul_f32 v18, v20, v24
    v_rcp_f32 v23, v23
    v_mul_f32 v19, v21, v24
    v_add_f32_dpp v16, v16, v16 quad_perm:[1,0,3,2] row_mask:0xf bank_mask:0xf
    v_add_f32_dpp v17, v17, v17 quad_perm:[1,0,3,2] row_mask:0xf bank_mask:0xf
    v_add_f32_dpp v18, v18, v18 quad_perm:[1,0,3,2] row_mask:0xf bank_mask:0xf
    v_add_f32_dpp v19, v19, v19 quad_perm:[1,0,3,2] row_mask:0xf bank_mask:0xf
    v_add_f32_dpp v16, v16, v16 quad_perm:[2,3,0,1] row_mask:0xf bank_mask:0xf
    v_add_f32_dpp v17, v17, v17 quad_perm:[2,3,0,1] row_mask:0xf bank_mask:0xf
    v_add_f32_dpp v18, v18, v18 quad_perm:[2,3,0,1] row_mask:0xf bank_mask:0xf
    v_add_f32_dpp v19, v19, v19 quad_perm:[2,3,0,1] row_mask:0xf bank_mask:0xf
    v_mul_f32 v16, v16, v23
    v_mul_f32 v17, v17, v23
    v_mul_f32 v18, v18, v23
    v_mul_f32 v19, v19, v23
    v_cvt_pk_bf16_f32 v24, v16, v17
    v_cvt_pk_bf16_f32 v25, v18, v19
    s_nop 1
    v_mov_b32_dpp v26, v24 row_half_mirror row_mask:0xf bank_mask:0xf
    v_mov_b32_dpp v27, v25 row_half_mirror row_mask:0xf bank_mask:0xf
    v_cndmask_b32 v28, v24, v26, s[42:43]
    v_cndmask_b32 v30, v26, v24, s[42:43]
    v_cndmask_b32 v29, v25, v27, s[42:43]
    v_cndmask_b32 v31, v27, v25, s[42:43]
    v_dot2c_f32_bf16 v40, v72, v28
    v_dot2c_f32_bf16 v41, v73, v28
    v_dot2c_f32_bf16 v48, v72, v30
    v_dot2c_f32_bf16 v49, v73, v30
    v_dot2c_f32_bf16 v42, v74, v28
    v_dot2c_f32_bf16 v43, v75, v28
    v_dot2c_f32_bf16 v50, v74, v30
    v_dot2c_f32_bf16 v51, v75, v30
    v_dot2c_f32_bf16 v44, v76, v28
    v_dot2c_f32_bf16 v45, v77, v28
    v_dot2c_f32_bf16 v52, v76, v30
    v_dot2c_f32_bf16 v53, v77, v30
    v_dot2c_f32_bf16 v46, v78, v28
    v_dot2c_f32_bf16 v47, v79, v28
    v_dot2c_f32_bf16 v54, v78, v30
    v_dot2c_f32_bf16 v55, v79, v30
    v_dot2c_f32_bf16 v40, v80, v29
    v_dot2c_f32_bf16 v41, v81, v29
    v_dot2c_f32_bf16 v48, v80, v31
    v_dot2c_f32_bf16 v49, v81, v31
    v_dot2c_f32_bf16 v42, v82, v29
    v_dot2c_f32_bf16 v43, v83, v29
    v_dot2c_f32_bf16 v50, v82, v31
    v_dot2c_f32_bf16 v51, v83, v31
    v_dot2c_f32_bf16 v44, v84, v29
    v_dot2c_f32_bf16 v45, v85, v29
    v_dot2c_f32_bf16 v52, v84, v31
    v_dot2c_f32_bf16 v53, v85, v31
    v_dot2c_f32_bf16 v46, v86, v29
    v_dot2c_f32_bf16 v47, v87, v29
    v_dot2c_f32_bf16 v54, v86, v31
    v_dot2c_f32_bf16 v55, v87, v31
    s_nop 2
    v_permlane32_swap_b32 v40, v48
    v_permlane32_swap_b32 v41, v49
    v_permlane32_swap_b32 v42, v50
    v_permlane32_swap_b32 v43, v51
    v_permlane32_swap_b32 v44, v52
    v_permlane32_swap_b32 v45, v53
    v_permlane32_swap_b32 v46, v54
    v_permlane32_swap_b32 v47, v55
    v_add_f32 v40, v40, v48
    v_add_f32 v41, v41, v49
    v_add_f32 v42, v42, v50
    v_add_f32 v43, v43, v51
    v_add_f32 v44, v44, v52
    v_add_f32 v45, v45, v53
    v_add_f32 v46, v46, v54
    v_add_f32 v47, v47, v55
    v_permlane16_swap_b32 v40, v44
    v_permlane16_swap_b32 v41, v45
    v_permlane16_swap_b32 v42, v46
    v_permlane16_swap_b32 v43, v47
    v_add_f32 v40, v40, v44
    v_add_f32 v41, v41, v45
    v_add_f32 v42, v42, v46
    v_add_f32 v43, v43, v47
    s_nop 1
    v_add_f32_dpp v40, v40, v40 row_ror:8 row_mask:0xf bank_mask:0xf
    v_add_f32_dpp v41, v41, v41 row_ror:8 row_mask:0xf bank_mask:0xf
    v_add_f32_dpp v42, v42, v42 row_ror:8 row_mask:0xf bank_mask:0xf
    v_add_f32_dpp v43, v43, v43 row_ror:8 row_mask:0xf bank_mask:0xf
    s_mov_b32 exec_lo, 0xff00ff
    s_mov_b32 exec_hi, 0xff00ff
    ds_write_b128 v93, v[40:43]
    s_mov_b64 exec, 1
    ds_add_rtn_u32 v3, v94, v95 offset:12
    s_mov_b64 exec, -1
    s_waitcnt lgkmcnt(0)
    v_readfirstlane_b32 s40, v3
    s_nop 0
    s_cmp_lg_u32 s40, 3
    s_cbranch_scc1 L_a_exit
    ds_read_b128 v[16:19], v8
    ds_read_b128 v[20:23], v8 offset:512
    ds_read_b128 v[24:27], v8 offset:1024
    ds_read_b128 v[28:31], v8 offset:1536
    s_waitcnt lgkmcnt(2)
    v_add_f32 v16, v16, v20
    v_add_f32 v17, v17, v21
    v_add_f32 v18, v18, v22
    v_add_f32 v19, v19, v23
    s_waitcnt lgkmcnt(0)
    v_add_f32 v24, v24, v28
    v_add_f32 v25, v25, v29
    v_add_f32 v26, v26, v30
    v_add_f32 v27, v27, v31
    v_add_f32 v16, v16, v24
    v_add_f32 v17, v17, v25
    v_add_f32 v18, v18, v26
    v_add_f32 v19, v19, v27
    v_perm_b32 v20, v19, v16, s60
    v_perm_b32 v21, v19, v17, s61
    v_perm_b32 v22, v19, v18, s62
    v_mov_b32 v23, s15
    s_mov_b64 exec, 0xffffffff
    global_store_dwordx4 v9, v[20:23], s[54:55]
    s_cmp_eq_u32 s59, -1
    s_cbranch_scc1 L_a_nowt
    global_store_dwordx4 v6, v[20:23], s[54:55] sc1
L_a_nowt:
    s_mov_b64 exec, -1
    s_mov_b32 s35, 0
    s_mov_b64 exec, 0xffffffff
L_a_fspin:
    global_load_dwordx4 v[20:23], v7, s[46:47] sc1
    s_add_u32 s35, s35, 1
    s_and_b32 s40, s35, 63
    s_cmp_eq_u32 s40, 0
    s_cbranch_scc0 L_a_fkeep
    v_mov_b32 v24, v7
    v_mov_b32 v7, v106
    v_mov_b32 v106, v24
L_a_fkeep:
    s_cmp_gt_u32 s35, 400000
    s_cbranch_scc1 L_end
    s_waitcnt vmcnt(0)
    v_cmp_ne_u32 vcc, s15, v23
    s_nop 0
    s_mov_b64 exec, vcc
    s_cbranch_execnz L_a_fspin
    s_mov_b64 exec, -1
L_a_fgot:
    v_perm_b32 v23, v20, v21, s63
    v_and_b32 v20, s65, v20
    v_and_b32 v21, s65, v21
    v_perm_b32 v23, v23, v22, s64
    v_and_b32 v22, s65, v22
    v_add_f32_dpp v20, v20, v20 row_ror:8 row_mask:0xf bank_mask:0xf
    v_add_f32_dpp v21, v21, v21 row_ror:8 row_mask:0xf bank_mask:0xf
    v_add_f32_dpp v22, v22, v22 row_ror:8 row_mask:0xf bank_mask:0xf
    v_add_f32_dpp v23, v23, v23 row_ror:8 row_mask:0xf bank_mask:0xf
    v_add_f32_dpp v20, v20, v20 row_ror:4 row_mask:0xf bank_mask:0xf
    v_add_f32_dpp v21, v21, v21 row_ror:4 row_mask:0xf bank_mask:0xf
    v_add_f32_dpp v22, v22, v22 row_ror:4 row_mask:0xf bank_mask:0xf
    v_add_f32_dpp v23, v23, v23 row_ror:4 row_mask:0xf bank_mask:0xf
    v_add_f32_dpp v20, v20, v20 row_ror:2 row_mask:0xf bank_mask:0xf
    v_add_f32_dpp v21, v21, v21 row_ror:2 row_mask:0xf bank_mask:0xf
    v_add_f32_dpp v22, v22, v22 row_ror:2 row_mask:0xf bank_mask:0xf
    v_add_f32_dpp v23, v23, v23 row_ror:2 row_mask:0xf bank_mask:0xf
    v_add_f32_dpp v20, v20, v20 row_ror:1 row_mask:0xf bank_mask:0xf
    v_add_f32_dpp v21, v21, v21 row_ror:1 row_mask:0xf bank_mask:0xf
    v_add_f32_dpp v22, v22, v22 row_ror:1 row_mask:0xf bank_mask:0xf
    v_add_f32_dpp v23, v23, v23 row_ror:1 row_mask:0xf bank_mask:0xf
    v_add_f32_dpp v20, v20, v20 row_bcast:15 row_mask:0xa bank_mask:0xf
    v_add_f32_dpp v21, v21, v21 row_bcast:15 row_mask:0xa bank_mask:0xf
    v_add_f32_dpp v22, v22, v22 row_bcast:15 row_mask:0xa bank_mask:0xf
    v_add_f32_dpp v23, v23, v23 row_bcast:15 row_mask:0xa bank_mask:0xf
    v_cvt_pk_bf16_f32 v20, v20, v21
    v_cvt_pk_bf16_f32 v21, v22, v23
    v_mov_b32 v1, 0
    s_mov_b64 exec, 0x10000
    global_store_dwordx2 v1, v[20:21], s[24:25]
    s_cmp_eq_u32 s2, 0
    s_cbranch_scc0 L_a_noep
    v_mov_b32 v2, 983040
    v_mov_b32 v3, s14
    global_store_dword v2, v3, s[28:29]
L_a_noep:
    s_mov_b64 exec, -1
L_a_exit:
    s_endpgm
L_stream:
    s_sub_u32 s34, s32, 4
    s_lshr_b32 s35, s31, 2
    s_and_b32 s35, s35, 1
    s_lshl_b32 s35, s35, 5
    s_add_u32 s35, s35, s33
    s_lshl_b32 s35, s35, 20
    s_and_b32 s36, s31, 3
    s_lshl_b32 s36, s36, 16
    s_add_u32 s35, s35, s36
    s_lshl_b32 s36, s34, 13
    s_add_u32 s35, s35, s36
    s_add_u32 s35, s35, 786432
    v_lshlrev_b32 v1, 4, v0
    s_mov_b32 s37, 0
    v_add_u32 v112, 0, v1
    v_add_u32 v113, 1024, v1
    v_add_u32 v114, 2048, v1
    v_add_u32 v115, 3072, v1
    v_add_u32 v116, 4096, v1
    v_add_u32 v117, 5120, v1
    v_add_u32 v118, 6144, v1
    v_add_u32 v119, 7168, v1
    v_mov_b32 v4, 0
    v_mov_b32 v5, 0
    v_mov_b32 v6, 0
    v_mov_b32 v7, 0
    v_mov_b32 v108, 0
    s_cmp_lg_u32 s34, 0
    s_cbranch_scc1 L_s_noinit
    ds_write_b128 v108, v[4:7]
    ds_write_b128 v108, v[4:7] offset:16
L_s_noinit:
    s_waitcnt lgkmcnt(0)
    s_load_dword s14, s[28:29], 983040
    s_add_u32 s6, s6, s35
    s_addc_u32 s7, s7, 0
    s_add_u32 s8, s8, s35
    s_addc_u32 s9, s9, 0
    s_barrier
    global_load_dwordx4 v[16:19], v112, s[6:7] nt
    global_load_dwordx4 v[20:23], v113, s[6:7] nt
    v_and_b32 v1, 15, v0
    v_lshlrev_b32 v104, 4, v1
    v_add_u32 v104, 128, v104
    v_mov_b32 v96, 0
    v_mov_b32 v97, 0
    v_mov_b32 v98, 0
    v_mov_b32 v99, 0
    v_mov_b32 v100, 0
    v_mov_b32 v101, 0
    v_mov_b32 v102, 0
    v_mov_b32 v103, 0
    v_mov_b32 v8, 0
    v_mov_b32 v9, 0
    v_mov_b32 v10, 0
    v_mov_b32 v11, 0
    v_mov_b32 v12, 0
    v_mov_b32 v13, 0
    v_mov_b32 v14, 0
    v_mov_b32 v15, 0
    v_lshrrev_b32 v105, 2, v1
    v_lshlrev_b32 v105, 5, v105
    v_and_b32 v106, 3, v1
    v_add_u32 v105, v105, v106
    v_lshrrev_b32 v106, 5, v0
    v_lshl_add_u32 v105, v106, 4, v105
    v_bfe_u32 v106, v0, 4, 1
    v_lshl_add_u32 v105, v106, 3, v105
    v_lshlrev_b32 v105, 2, v105
    s_lshl_b32 s36, s34, 9
    s_add_u32 s36, s36, 6656
    v_add_u32 v105, s36, v105
    s_lshl_b32 s37, s34, 2
    s_add_u32 s37, s37, 64
    v_mov_b32 v107, s37
    v_mov_b32 v109, 1
    s_mov_b32 s40, 0x3e0293ee
    v_and_b32 v1, 31, v0
    v_lshlrev_b32 v2, 4, v1
    v_lshrrev_b32 v3, 5, v0
    v_lshlrev_b32 v106, 4, v3
    v_lshlrev_b32 v3, 11, v3
    v_add_u32 v3, v3, v2
    v_add_u32 v3, 6656, v3
    s_and_b32 s36, s31, 7
    s_lshl_b32 s35, s33, 3
    s_add_u32 s35, s35, s36
    s_lshl_b32 s36, s35, 9
    s_add_u32 s36, s36, 524288
    s_add_u32 s44, s28, s36
    s_addc_u32 s45, s29, 0
    s_waitcnt lgkmcnt(0)
    s_add_u32 s14, s14, 1
    s_xor_b32 s15, s14, 0x5bd1e995
    s_cmp_lt_u32 s31, 11
    s_waitcnt vmcnt(1)
    global_load_dwordx4 v[24:27], v114, s[6:7] nt
    s_waitcnt vmcnt(1)
    global_load_dwordx4 v[28:31], v115, s[6:7] nt
    s_waitcnt vmcnt(1)
    global_load_dwordx4 v[32:35], v116, s[6:7] nt
    s_waitcnt vmcnt(1)
    global_load_dwordx4 v[36:39], v117, s[6:7] nt
    s_waitcnt vmcnt(1)
    global_load_dwordx4 v[40:43], v118, s[6:7] nt
    s_waitcnt vmcnt(1)
    global_load_dwordx4 v[44:47], v119, s[6:7] nt
    s_cbranch_scc1 L_s_hw8
    s_waitcnt vmcnt(4)
L_s_hw8:
    s_waitcnt vmcnt(5)
    global_load_dwordx4 v[48:51], v112, s[8:9] nt
    s_cbranch_scc1 L_s_hw9
    s_waitcnt vmcnt(4)
L_s_hw9:
    s_waitcnt vmcnt(5)
    global_load_dwordx4 v[52:55], v113, s[8:9] nt
    s_cbranch_scc1 L_s_hw10
    s_waitcnt vmcnt(4)
L_s_hw10:
    s_waitcnt vmcnt(5)
    global_load_dwordx4 v[56:59], v114, s[8:9] nt
    s_cbranch_scc1 L_s_hw11
    s_waitcnt vmcnt(4)
L_s_hw11:
    s_waitcnt vmcnt(5)
    global_load_dwordx4 v[60:63], v115, s[8:9] nt
    s_cbranch_scc1 L_s_hw12
    s_waitcnt vmcnt(4)
L_s_hw12:
    s_waitcnt vmcnt(5)
    global_load_dwordx4 v[64:67], v116, s[8:9] nt
    ds_read_b32 v111, v108 offset:20
    s_waitcnt lgkmcnt(0)
    v_readfirstlane_b32 s42, v111
    s_nop 0
    s_cmp_eq_u32 s42, 0
    s_cbranch_scc1 L_s_noearly
    s_setprio 2
    ds_read_b128 v[4:7], v104
    s_waitcnt vmcnt(5) lgkmcnt(0)
    v_dot2c_f32_bf16 v8, v16, v4
    v_dot2c_f32_bf16 v9, v20, v4
    v_dot2c_f32_bf16 v10, v24, v4
    v_dot2c_f32_bf16 v11, v28, v4
    v_dot2c_f32_bf16 v12, v32, v4
    v_dot2c_f32_bf16 v13, v36, v4
    v_dot2c_f32_bf16 v14, v40, v4
    v_dot2c_f32_bf16 v15, v44, v4
    v_dot2c_f32_bf16 v8, v17, v5
    v_dot2c_f32_bf16 v9, v21, v5
    v_dot2c_f32_bf16 v10, v25, v5
    v_dot2c_f32_bf16 v11, v29, v5
    v_dot2c_f32_bf16 v12, v33, v5
    v_dot2c_f32_bf16 v13, v37, v5
    v_dot2c_f32_bf16 v14, v41, v5
    v_dot2c_f32_bf16 v15, v45, v5
    v_dot2c_f32_bf16 v8, v18, v6
    v_dot2c_f32_bf16 v9, v22, v6
    v_dot2c_f32_bf16 v10, v26, v6
    v_dot2c_f32_bf16 v11, v30, v6
    v_dot2c_f32_bf16 v12, v34, v6
    v_dot2c_f32_bf16 v13, v38, v6
    v_dot2c_f32_bf16 v14, v42, v6
    v_dot2c_f32_bf16 v15, v46, v6
    v_dot2c_f32_bf16 v8, v19, v7
    v_dot2c_f32_bf16 v9, v23, v7
    v_dot2c_f32_bf16 v10, v27, v7
    v_dot2c_f32_bf16 v11, v31, v7
    v_dot2c_f32_bf16 v12, v35, v7
    v_dot2c_f32_bf16 v13, v39, v7
    v_dot2c_f32_bf16 v14, v43, v7
    v_dot2c_f32_bf16 v15, v47, v7
    s_nop 2
    v_add_f32_dpp v8, v8, v8 row_ror:8 row_mask:0xf bank_mask:0x3
    v_add_f32_dpp v9, v9, v9 row_ror:8 row_mask:0xf bank_mask:0x3
    v_add_f32_dpp v10, v10, v10 row_ror:8 row_mask:0xf bank_mask:0x3
    v_add_f32_dpp v11, v11, v11 row_ror:8 row_mask:0xf bank_mask:0x3
    v_add_f32_dpp v8, v12, v12 row_ror:8 row_mask:0xf bank_mask:0xc
    v_add_f32_dpp v9, v13, v13 row_ror:8 row_mask:0xf bank_mask:0xc
    v_add_f32_dpp v10, v14, v14 row_ror:8 row_mask:0xf bank_mask:0xc
    v_add_f32_dpp v11, v15, v15 row_ror:8 row_mask:0xf bank_mask:0xc
    v_add_f32_dpp v8, v8, v8 row_shl:4 row_mask:0xf bank_mask:0x5
    v_add_f32_dpp v9, v9, v9 row_shl:4 row_mask:0xf bank_mask:0x5
    v_add_f32_dpp v8, v10, v10 row_shr:4 row_mask:0xf bank_mask:0xa
    v_add_f32_dpp v9, v11, v11 row_shr:4 row_mask:0xf bank_mask:0xa
    s_nop 0
    v_add_f32_dpp v8, v8, v8 quad_perm:[1,0,3,2] row_mask:0xf bank_mask:0xf
    v_add_f32_dpp v9, v9, v9 quad_perm:[1,0,3,2] row_mask:0xf bank_mask:0xf
    s_nop 0
    v_add_f32_dpp v8, v8, v8 quad_perm:[2,3,0,1] row_mask:0xf bank_mask:0xf
    v_add_f32_dpp v9, v9, v9 quad_perm:[2,3,0,1] row_mask:0xf bank_mask:0xf
    s_nop 0
    v_max_f32 v110, v8, v9
    s_nop 1
    v_max_f32_dpp v110, v110, v110 row_ror:8 row_mask:0xf bank_mask:0xf
    s_nop 1
    v_max_f32_dpp v110, v110, v110 row_ror:4 row_mask:0xf bank_mask:0xf
    v_mov_b32 v111, v110
    s_nop 1
    v_permlane32_swap_b32 v110, v111
    v_max_f32 v110, v110, v111
    v_mov_b32 v111, v110
    s_nop 1
    v_permlane16_swap_b32 v110, v111
    v_max_f32 v110, v110, v111
    v_mul_f32 v110, s40, v110
    v_fma_f32 v8, v8, s40, -v110
    v_fma_f32 v9, v9, s40, -v110
    v_exp_f32 v8, v8
    v_exp_f32 v9, v9
    s_nop 0
    v_cvt_pk_bf16_f32 v12, v8, 0
    v_cvt_pk_bf16_f32 v13, v9, 0
    v_add_f32 v111, v8, v9
    v_lshlrev_b32 v14, 16, v12
    v_lshlrev_b32 v15, 16, v13
    v_add_f32_dpp v111, v111, v111 row_ror:8 row_mask:0xf bank_mask:0xf
    v_mov_b32_dpp v80, v12 row_newbcast:0 row_mask:0xf bank_mask:0xf
    v_mov_b32_dpp v88, v14 row_newbcast:0 row_mask:0xf bank_mask:0xf
    v_add_f32_dpp v111, v111, v111 row_ror:4 row_mask:0xf bank_mask:0xf
    v_mov_b32_dpp v81, v13 row_newbcast:0 row_mask:0xf bank_mask:0xf
    v_mov_b32_dpp v89, v15 row_newbcast:0 row_mask:0xf bank_mask:0xf
    v_add_f32_dpp v111, v111, v111 row_bcast:15 row_mask:0xa bank_mask:0xf
    v_mov_b32_dpp v82, v12 row_newbcast:4 row_mask:0xf bank_mask:0xf
    v_mov_b32_dpp v90, v14 row_newbcast:4 row_mask:0xf bank_mask:0xf
    v_add_f32_dpp v111, v111, v111 row_bcast:31 row_mask:0xc bank_mask:0xf
    v_mov_b32_dpp v83, v13 row_newbcast:4 row_mask:0xf bank_mask:0xf
    v_mov_b32_dpp v91, v15 row_newbcast:4 row_mask:0xf bank_mask:0xf
    v_mov_b32_dpp v84, v12 row_newbcast:8 row_mask:0xf bank_mask:0xf
    v_mov_b32_dpp v92, v14 row_newbcast:8 row_mask:0xf bank_mask:0xf
    v_mov_b32_dpp v85, v13 row_newbcast:8 row_mask:0xf bank_mask:0xf
    v_mov_b32_dpp v93, v15 row_newbcast:8 row_mask:0xf bank_mask:0xf
    v_mov_b32_dpp v86, v12 row_newbcast:12 row_mask:0xf bank_mask:0xf
    v_mov_b32_dpp v94, v14 row_newbcast:12 row_mask:0xf bank_mask:0xf
    v_mov_b32_dpp v87, v13 row_newbcast:12 row_mask:0xf bank_mask:0xf
    v_mov_b32_dpp v95, v15 row_newbcast:12 row_mask:0xf bank_mask:0xf
    s_mov_b32 exec_lo, 0
    s_mov_b32 exec_hi, 0x80000000
    ds_write_b32 v107, v110
    ds_write_b32 v107, v111 offset:32
    s_mov_b64 exec, -1
L_s_noearly:
    s_cmp_lt_u32 s31, 11
    s_cbranch_scc1 L_s_hw13
    s_waitcnt vmcnt(4)
L_s_hw13:
    s_waitcnt vmcnt(5)
    global_load_dwordx4 v[68:71], v117, s[8:9] nt
    s_cbranch_scc1 L_s_hw14
    s_waitcnt vmcnt(4)
L_s_hw14:
    s_waitcnt vmcnt(5)
    global_load_dwordx4 v[72:75], v118, s[8:9] nt
    s_cbranch_scc1 L_s_hw15
    s_waitcnt vmcnt(4)
L_s_hw15:
    s_waitcnt vmcnt(5)
    global_load_dwordx4 v[76:79], v119, s[8:9] nt
    s_mov_b64 exec, 1
    ds_add_u32 v108, v109 offset:4
    s_mov_b64 exec, -1
    s_cmp_eq_u32 s42, 0
    s_cbranch_scc0 L_s_qkdone
    s_mov_b32 s41, 0
L_s_qspin:
    ds_read_b32 v111, v108 offset:20
    s_add_u32 s41, s41, 1
    s_cmp_gt_u32 s41, 400000
    s_cbranch_scc1 L_end
    s_waitcnt lgkmcnt(0)
    v_readfirstlane_b32 s43, v111
    s_nop 0
    s_cmp_eq_u32 s43, 0
    s_cbranch_scc1 L_s_qspin
    s_setprio 2
    ds_read_b128 v[4:7], v104
    s_waitcnt vmcnt(8) lgkmcnt(0)
    v_dot2c_f32_bf16 v8, v16, v4
    v_dot2c_f32_bf16 v9, v20, v4
    v_dot2c_f32_bf16 v10, v24, v4
    v_dot2c_f32_bf16 v11, v28, v4
    v_dot2c_f32_bf16 v12, v32, v4
    v_dot2c_f32_bf16 v13, v36, v4
    v_dot2c_f32_bf16 v14, v40, v4
    v_dot2c_f32_bf16 v15, v44, v4
    v_dot2c_f32_bf16 v8, v17, v5
    v_dot2c_f32_bf16 v9, v21, v5
    v_dot2c_f32_bf16 v10, v25, v5
    v_dot2c_f32_bf16 v11, v29, v5
    v_dot2c_f32_bf16 v12, v33, v5
    v_dot2c_f32_bf16 v13, v37, v5
    v_dot2c_f32_bf16 v14, v41, v5
    v_dot2c_f32_bf16 v15, v45, v5
    v_dot2c_f32_bf16 v8, v18, v6
    v_dot2c_f32_bf16 v9, v22, v6
    v_dot2c_f32_bf16 v10, v26, v6
    v_dot2c_f32_bf16 v11, v30, v6
    v_dot2c_f32_bf16 v12, v34, v6
    v_dot2c_f32_bf16 v13, v38, v6
    v_dot2c_f32_bf16 v14, v42, v6
    v_dot2c_f32_bf16 v15, v46, v6
    v_dot2c_f32_bf16 v8, v19, v7
    v_dot2c_f32_bf16 v9, v23, v7
    v_dot2c_f32_bf16 v10, v27, v7
    v_dot2c_f32_bf16 v11, v31, v7
    v_dot2c_f32_bf16 v12, v35, v7
    v_dot2c_f32_bf16 v13, v39, v7
    v_dot2c_f32_bf16 v14, v43, v7
    v_dot2c_f32_bf16 v15, v47, v7
    s_nop 2
    v_add_f32_dpp v8, v8, v8 row_ror:8 row_mask:0xf bank_mask:0x3
    v_add_f32_dpp v9, v9, v9 row_ror:8 row_mask:0xf bank_mask:0x3
    v_add_f32_dpp v10, v10, v10 row_ror:8 row_mask:0xf bank_mask:0x3
    v_add_f32_dpp v11, v11, v11 row_ror:8 row_mask:0xf bank_mask:0x3
    v_add_f32_dpp v8, v12, v12 row_ror:8 row_mask:0xf bank_mask:0xc
    v_add_f32_dpp v9, v13, v13 row_ror:8 row_mask:0xf bank_mask:0xc
    v_add_f32_dpp v10, v14, v14 row_ror:8 row_mask:0xf bank_mask:0xc
    v_add_f32_dpp v11, v15, v15 row_ror:8 row_mask:0xf bank_mask:0xc
    v_add_f32_dpp v8, v8, v8 row_shl:4 row_mask:0xf bank_mask:0x5
    v_add_f32_dpp v9, v9, v9 row_shl:4 row_mask:0xf bank_mask:0x5
    v_add_f32_dpp v8, v10, v10 row_shr:4 row_mask:0xf bank_mask:0xa
    v_add_f32_dpp v9, v11, v11 row_shr:4 row_mask:0xf bank_mask:0xa
    s_nop 0
    v_add_f32_dpp v8, v8, v8 quad_perm:[1,0,3,2] row_mask:0xf bank_mask:0xf
    v_add_f32_dpp v9, v9, v9 quad_perm:[1,0,3,2] row_mask:0xf bank_mask:0xf
    s_nop 0
    v_add_f32_dpp v8, v8, v8 quad_perm:[2,3,0,1] row_mask:0xf bank_mask:0xf
    v_add_f32_dpp v9, v9, v9 quad_perm:[2,3,0,1] row_mask:0xf bank_mask:0xf
    s_nop 0
    v_max_f32 v110, v8, v9
    s_nop 1
    v_max_f32_dpp v110, v110, v110 row_ror:8 row_mask:0xf bank_mask:0xf
    s_nop 1
    v_max_f32_dpp v110, v110, v110 row_ror:4 row_mask:0xf bank_mask:0xf
    v_mov_b32 v111, v110
    s_nop 1
    v_permlane32_swap_b32 v110, v111
    v_max_f32 v110, v110, v111
    v_mov_b32 v111, v110
    s_nop 1
    v_permlane16_swap_b32 v110, v111
    v_max_f32 v110, v110, v111
    v_mul_f32 v110, s40, v110
    v_fma_f32 v8, v8, s40, -v110
    v_fma_f32 v9, v9, s40, -v110
    v_exp_f32 v8, v8
    v_exp_f32 v9, v9
    s_nop 0
    v_cvt_pk_bf16_f32 v12, v8, 0
    v_cvt_pk_bf16_f32 v13, v9, 0
    v_add_f32 v111, v8, v9
    v_lshlrev_b32 v14, 16, v12
    v_lshlrev_b32 v15, 16, v13
    v_add_f32_dpp v111, v111, v111 row_ror:8 row_mask:0xf bank_mask:0xf
    v_mov_b32_dpp v80, v12 row_newbcast:0 row_mask:0xf bank_mask:0xf
    v_mov_b32_dpp v88, v14 row_newbcast:0 row_mask:0xf bank_mask:0xf
    v_add_f32_dpp v111, v111, v111 row_ror:4 row_mask:0xf bank_mask:0xf
    v_mov_b32_dpp v81, v13 row_newbcast:0 row_mask:0xf bank_mask:0xf
    v_mov_b32_dpp v89, v15 row_newbcast:0 row_mask:0xf bank_mask:0xf
    v_add_f32_dpp v111, v111, v111 row_bcast:15 row_mask:0xa bank_mask:0xf
    v_mov_b32_dpp v82, v12 row_newbcast:4 row_mask:0xf bank_mask:0xf
    v_mov_b32_dpp v90, v14 row_newbcast:4 row_mask:0xf bank_mask:0xf
    v_add_f32_dpp v111, v111, v111 row_bcast:31 row_mask:0xc bank_mask:0xf
    v_mov_b32_dpp v83, v13 row_newbcast:4 row_mask:0xf bank_mask:0xf
    v_mov_b32_dpp v91, v15 row_newbcast:4 row_mask:0xf bank_mask:0xf
    v_mov_b32_dpp v84, v12 row_newbcast:8 row_mask:0xf bank_mask:0xf
    v_mov_b32_dpp v92, v14 row_newbcast:8 row_mask:0xf bank_mask:0xf
    v_mov_b32_dpp v85, v13 row_newbcast:8 row_mask:0xf bank_mask:0xf
    v_mov_b32_dpp v93, v15 row_newbcast:8 row_mask:0xf bank_mask:0xf
    v_mov_b32_dpp v86, v12 row_newbcast:12 row_mask:0xf bank_mask:0xf
    v_mov_b32_dpp v94, v14 row_newbcast:12 row_mask:0xf bank_mask:0xf
    v_mov_b32_dpp v87, v13 row_newbcast:12 row_mask:0xf bank_mask:0xf
    v_mov_b32_dpp v95, v15 row_newbcast:12 row_mask:0xf bank_mask:0xf
    s_mov_b32 exec_lo, 0
    s_mov_b32 exec_hi, 0x80000000
    ds_write_b32 v107, v110
    ds_write_b32 v107, v111 offset:32
    s_mov_b64 exec, -1
L_s_qkdone:
    s_waitcnt vmcnt(7)
    v_dot2c_f32_bf16 v96, v48, v80
    v_dot2c_f32_bf16 v97, v48, v88
    v_dot2c_f32_bf16 v98, v49, v80
    v_dot2c_f32_bf16 v99, v49, v88
    v_dot2c_f32_bf16 v100, v50, v80
    v_dot2c_f32_bf16 v101, v50, v88
    v_dot2c_f32_bf16 v102, v51, v80
    v_dot2c_f32_bf16 v103, v51, v88
    s_waitcnt vmcnt(6)
    v_dot2c_f32_bf16 v96, v52, v81
    v_dot2c_f32_bf16 v97, v52, v89
    v_dot2c_f32_bf16 v98, v53, v81
    v_dot2c_f32_bf16 v99, v53, v89
    v_dot2c_f32_bf16 v100, v54, v81
    v_dot2c_f32_bf16 v101, v54, v89
    v_dot2c_f32_bf16 v102, v55, v81
    v_dot2c_f32_bf16 v103, v55, v89
    s_waitcnt vmcnt(5)
    v_dot2c_f32_bf16 v96, v56, v82
    v_dot2c_f32_bf16 v97, v56, v90
    v_dot2c_f32_bf16 v98, v57, v82
    v_dot2c_f32_bf16 v99, v57, v90
    v_dot2c_f32_bf16 v100, v58, v82
    v_dot2c_f32_bf16 v101, v58, v90
    v_dot2c_f32_bf16 v102, v59, v82
    v_dot2c_f32_bf16 v103, v59, v90
    s_waitcnt vmcnt(4)
    v_dot2c_f32_bf16 v96, v60, v83
    v_dot2c_f32_bf16 v97, v60, v91
    v_dot2c_f32_bf16 v98, v61, v83
    v_dot2c_f32_bf16 v99, v61, v91
    v_dot2c_f32_bf16 v100, v62, v83
    v_dot2c_f32_bf16 v101, v62, v91
    v_dot2c_f32_bf16 v102, v63, v83
    v_dot2c_f32_bf16 v103, v63, v91
    s_waitcnt vmcnt(3)
    v_dot2c_f32_bf16 v96, v64, v84
    v_dot2c_f32_bf16 v97, v64, v92
    v_dot2c_f32_bf16 v98, v65, v84
    v_dot2c_f32_bf16 v99, v65, v92
    v_dot2c_f32_bf16 v100, v66, v84
    v_dot2c_f32_bf16 v101, v66, v92
    v_dot2c_f32_bf16 v102, v67, v84
    v_dot2c_f32_bf16 v103, v67, v92
    s_waitcnt vmcnt(2)
    v_dot2c_f32_bf16 v96, v68, v85
    v_dot2c_f32_bf16 v97, v68, v93
    v_dot2c_f32_bf16 v98, v69, v85
    v_dot2c_f32_bf16 v99, v69, v93
    v_dot2c_f32_bf16 v100, v70, v85
    v_dot2c_f32_bf16 v101, v70, v93
    v_dot2c_f32_bf16 v102, v71, v85
    v_dot2c_f32_bf16 v103, v71, v93
    s_waitcnt vmcnt(1)
    v_dot2c_f32_bf16 v96, v72, v86
    v_dot2c_f32_bf16 v97, v72, v94
    v_dot2c_f32_bf16 v98, v73, v86
    v_dot2c_f32_bf16 v99, v73, v94
    v_dot2c_f32_bf16 v100, v74, v86
    v_dot2c_f32_bf16 v101, v74, v94
    v_dot2c_f32_bf16 v102, v75, v86
    v_dot2c_f32_bf16 v103, v75, v94
    s_waitcnt vmcnt(0)
    v_dot2c_f32_bf16 v96, v76, v87
    v_dot2c_f32_bf16 v97, v76, v95
    v_dot2c_f32_bf16 v98, v77, v87
    v_dot2c_f32_bf16 v99, v77, v95
    v_dot2c_f32_bf16 v100, v78, v87
    v_dot2c_f32_bf16 v101, v78, v95
    v_dot2c_f32_bf16 v102, v79, v87
    v_dot2c_f32_bf16 v103, v79, v95
    s_nop 2
    v_permlane32_swap_b32 v96, v100
    v_permlane32_swap_b32 v97, v101
    v_permlane32_swap_b32 v98, v102
    v_permlane32_swap_b32 v99, v103
    v_add_f32 v96, v96, v100
    v_add_f32 v97, v97, v101
    v_add_f32 v98, v98, v102
    v_add_f32 v99, v99, v103
    s_nop 0
    v_permlane16_swap_b32 v96, v98
    v_permlane16_swap_b32 v97, v99
    s_nop 0
    v_add_f32 v96, v96, v98
    v_add_f32 v97, v97, v99
    ds_write2_b32 v105, v96, v97 offset0:0 offset1:4
    s_mov_b64 exec, 1
    ds_add_rtn_u32 v111, v108, v109 offset:8
    s_mov_b64 exec, -1
    s_waitcnt lgkmcnt(0)
    v_readfirstlane_b32 s42, v111
    s_nop 0
    s_cmp_lg_u32 s42, 7
    s_cbranch_scc1 L_s_exit
    ds_read_b128 v[20:23], v108 offset:64
    ds_read_b128 v[24:27], v108 offset:80
    ds_read_b128 v[28:31], v106 offset:64
    ds_read_b128 v[32:35], v106 offset:96
    ds_read_b128 v[4:7], v3
    ds_read_b128 v[8:11], v3 offset:512
    ds_read_b128 v[12:15], v3 offset:1024
    ds_read_b128 v[16:19], v3 offset:1536
    s_waitcnt lgkmcnt(5)
    v_max3_f32 v20, v20, v21, v22
    v_max3_f32 v24, v24, v25, v26
    v_max3_f32 v20, v20, v23, v27
    v_max_f32 v110, v20, v24
    v_sub_f32 v28, v28, v110
    v_sub_f32 v29, v29, v110
    v_sub_f32 v30, v30, v110
    v_sub_f32 v31, v31, v110
    v_exp_f32 v28, v28
    v_exp_f32 v29, v29
    v_exp_f32 v30, v30
    v_exp_f32 v31, v31
    s_waitcnt lgkmcnt(3)
    v_mul_f32 v20, v28, v32
    v_mul_f32 v4, v4, v28
    v_mul_f32 v5, v5, v28
    v_mul_f32 v6, v6, v28
    v_mul_f32 v7, v7, v28
    v_fmac_f32 v20, v29, v33
    s_waitcnt lgkmcnt(2)
    v_fmac_f32 v4, v8, v29
    v_fmac_f32 v5, v9, v29
    v_fmac_f32 v6, v10, v29
    v_fmac_f32 v7, v11, v29
    v_fmac_f32 v20, v30, v34
    s_waitcnt lgkmcnt(1)
    v_fmac_f32 v4, v12, v30
    v_fmac_f32 v5, v13, v30
    v_fmac_f32 v6, v14, v30
    v_fmac_f32 v7, v15, v30
    v_fmac_f32 v20, v31, v35
    s_waitcnt lgkmcnt(0)
    v_fmac_f32 v4, v16, v31
    v_mov_b32 v21, v20
    v_fmac_f32 v5, v17, v31
    v_fmac_f32 v6, v18, v31
    v_fmac_f32 v7, v19, v31
    v_permlane32_swap_b32 v20, v21
    v_mov_b32 v8, v4
    v_mov_b32 v9, v5
    v_add_f32 v20, v20, v21
    v_mov_b32 v12, v6
    v_mov_b32 v13, v7
    v_rcp_f32 v21, v20
    v_log_f32 v22, v20
    v_permlane32_swap_b32 v4, v8
    v_permlane32_swap_b32 v5, v9
    v_permlane32_swap_b32 v6, v12
    v_permlane32_swap_b32 v7, v13
    v_add_f32 v10, v110, v22
    v_add_f32 v4, v4, v8
    v_add_f32 v5, v5, v9
    v_add_f32 v6, v6, v12
    v_add_f32 v7, v7, v13
    v_mul_f32 v4, v4, v21
    v_mul_f32 v5, v5, v21
    v_mul_f32 v6, v6, v21
    v_mul_f32 v7, v7, v21
    v_mov_b32 v11, s15
    v_cvt_pk_bf16_f32 v8, v4, v5
    v_cvt_pk_bf16_f32 v9, v6, v7
    s_mov_b64 exec, 0xffffffff
    global_store_dwordx4 v2, v[8:11], s[44:45] sc1
    s_mov_b64 exec, 1
    s_mov_b64 exec, -1
L_s_exit:
L_end:
    s_endpgm
.section .rodata,"a"
.p2align 6
.amdhsa_kernel gated_mix__sliding_block_cached__glu_gated_reglu__decode_kernel
  .amdhsa_next_free_vgpr 128
  .amdhsa_next_free_sgpr 102
  .amdhsa_accum_offset 128
  .amdhsa_group_segment_fixed_size 0
  .amdhsa_kernarg_size 104
  .amdhsa_user_sgpr_count 2
  .amdhsa_user_sgpr_kernarg_segment_ptr 1
  .amdhsa_system_sgpr_workgroup_id_x 1
.end_amdhsa_kernel
```
